```python
import torch

def _softmax(x, axis=-1):
    return torch.softmax(x, dim=axis)
def _gelu(x):
    return torch.nn.functional.gelu(x, approximate="tanh")
def _silu(x):
    return torch.nn.functional.silu(x)
def _sigmoid(x):
    return torch.sigmoid(x)
def _layernorm(x, axis=-1, eps=1e-5):
    m = x.mean(dim=axis, keepdim=True)
    v = x.var(dim=axis, keepdim=True, unbiased=False)
    return (x - m) / torch.sqrt(v + eps)
def _scatter_add(tgt, idx, src, axis=0):
    return tgt.clone().index_add_(axis, idx, src)
def _segment_sum(src, seg, n):
    out = torch.zeros((n,) + src.shape[1:], dtype=src.dtype)
    return out.index_add_(0, seg, src)
def _pad(x, pw):
    flat = tuple(v for pair in reversed(pw) for v in pair)
    return torch.nn.functional.pad(x, flat)

kernel_name = 'concat_heads__spectral_gfnet__ssm_conv_s4__prompt'

def setup_inputs():

    _w = (lambda a: (lambda t: t.to(torch.bfloat16) if t.is_floating_point() else t)(torch.as_tensor(a)))
    def _A_setup():
        B, S, D = 1, 2048, 1024
        Df = D // 2 + 1
        return {
            "x": _w((lambda *s: torch.randn(*s, dtype=torch.bfloat16) * 0.05)(B, S, D)),
            "w_r": _w((lambda *s: torch.randn(*s, dtype=torch.bfloat16) * 1.6)(S, Df) * 0.02),
            "w_i": _w((lambda *s: torch.randn(*s, dtype=torch.bfloat16) * 1.6)(S, Df) * 0.02),
        }
    _A_in = _A_setup()

    def _B_setup():
        B, L, D, N = 1, 2048, 1024, 128
        A_re = -(lambda _x: torch.exp(torch.as_tensor(_x)))((lambda *s: torch.randn(*s, dtype=torch.bfloat16) * 3.2)(D, N))
        A_im = torch.pi * (lambda *s: torch.randn(*s, dtype=torch.bfloat16) * 0.05)(D, N)
        B_re = (lambda *s: torch.randn(*s, dtype=torch.bfloat16) * 0.1)(D, N)
        B_im = (lambda *s: torch.randn(*s, dtype=torch.bfloat16) * 0.1)(D, N)
        C_re = (lambda *s: torch.randn(*s, dtype=torch.bfloat16) * 0.1)(D, N)
        C_im = (lambda *s: torch.randn(*s, dtype=torch.bfloat16) * 0.1)(D, N)
        log_dt = (lambda *s: torch.randn(*s, dtype=torch.bfloat16) * 0.05)(D) * 0.5 - 4.0
        Dskip = (lambda *s: torch.randn(*s, dtype=torch.bfloat16) * 0.05)(D)
        return {
            "u": _w((lambda *s: torch.randn(*s, dtype=torch.bfloat16) * 0.05)(B, L, D)),
            "A_re": _w(A_re),
            "A_im": _w(A_im),
            "B_re": _w(B_re),
            "B_im": _w(B_im),
            "C_re": _w(C_re),
            "C_im": _w(C_im),
            "log_dt": _w(log_dt),
            "Dskip": _w(Dskip),
        }
    _B_in = _B_setup()

    return {
        "A_x": _A_in["x"],
        "A_w_r": _A_in["w_r"],
        "A_w_i": _A_in["w_i"],
        "B_u": _B_in["u"],
        "B_A_re": _B_in["A_re"],
        "B_A_im": _B_in["A_im"],
        "B_B_re": _B_in["B_re"],
        "B_B_im": _B_in["B_im"],
        "B_C_re": _B_in["C_re"],
        "B_C_im": _B_in["C_im"],
        "B_log_dt": _B_in["log_dt"],
        "B_Dskip": _B_in["Dskip"],
    }

def reference(A_x, A_w_r, A_w_i, B_u, B_A_re, B_A_im, B_B_re, B_B_im, B_C_re, B_C_im, B_log_dt, B_Dskip):
    def _A_ref(x, w_r, w_i):
        B, S, D = x.shape
        X = (lambda x, axes=(-2,-1): torch.fft.rfft2(x.float(), dim=axes))(x, axes=(-2, -1))
        W = w_r + 1j * w_i
        X = X * W
        y = (lambda x, s, axes=(-2,-1): torch.fft.irfft2(x, s=s, dim=axes).to(torch.bfloat16))(X, (S, D), axes=(-2, -1))
        return y

    def _B_ref(u, A_re, A_im, B_re, B_im, C_re, C_im, log_dt, Dskip):
        Bsz, L, D = u.shape
        dt = torch.exp(log_dt)[:, None]
        A = A_re + 1j * A_im
        Bc = B_re + 1j * B_im
        Cc = C_re + 1j * C_im
        logdA = dt * A
        dB = dt * Bc
        l = (lambda x, dt: x.to(dt))(torch.arange(L), A_re.dtype)
        P = torch.exp(logdA[:, :, None] * l[None, None, :])
        K = torch.einsum("dn,dnl,dn->dl", Cc, P, dB).real
        L2 = 2 * L
        Kp = _pad(K, ((0, 0), (0, L)))
        up = (lambda x, *d: x.permute(*d))(u, 0, 2, 1)
        up = _pad(up, ((0, 0), (0, 0), (0, L)))
        Kf = (lambda x, axes=(-2,-1): torch.fft.rfft2(x.float(), dim=axes))(Kp[:, None, :], axes=(-2, -1))
        Uf = (lambda x, axes=(-2,-1): torch.fft.rfft2(x.float(), dim=axes))(up[:, :, None, :], axes=(-2, -1))
        Yf = Uf * Kf[None, :, :, :]
        y = (lambda x, s, axes=(-2,-1): torch.fft.irfft2(x, s=s, dim=axes).to(torch.bfloat16))(Yf, (1, L2), axes=(-2, -1))[:, :, 0, :L]
        y = (lambda x, *d: x.permute(*d))(y, 0, 2, 1) + u * Dskip[None, None, :]
        return y

    a = _A_ref(A_x, A_w_r, A_w_i)
    b = _B_ref(B_u, B_A_re, B_A_im, B_B_re, B_B_im, B_C_re, B_C_im, B_log_dt, B_Dskip)
    return torch.concatenate([a, b], axis=-1)
```

```asm
; @launch grid=(256,1,1) block=(512,1,1) lds=159360
.amdgcn_target "amdgcn-amd-amdhsa--gfx950"
.text
.globl concat_heads__spectral_gfnet__ssm_conv_s4__prompt_kernel
.p2align 8
.type concat_heads__spectral_gfnet__ssm_conv_s4__prompt_kernel,@function
concat_heads__spectral_gfnet__ssm_conv_s4__prompt_kernel:
  s_cmp_ge_u32 s2, 256
  s_cbranch_scc1 L_exit
  s_cmp_lt_u32 s2, 128
  s_cbranch_scc1 L_A
L_B:
  s_load_dwordx4 s[40:43], s[0:1], 32
  s_load_dwordx4 s[44:47], s[0:1], 48
  s_load_dwordx4 s[48:51], s[0:1], 64
  s_load_dwordx4 s[52:55], s[0:1], 80
  s_load_dwordx2 s[8:9], s[0:1], 24
  s_load_dwordx2 s[20:21], s[0:1], 96
  s_getpc_b64 s[28:29]
L_B_pc:
  s_add_u32 s28, s28, (L_B_body-L_B_pc)
  s_addc_u32 s29, s29, 0
  v_lshlrev_b32 v250, 7, v0
  v_cmp_gt_u32 vcc, (L_B_end-L_B_body-4), v250
  s_nop 0
  s_and_saveexec_b64 s[30:31], vcc
  s_cbranch_execz Lskip_1001
  global_load_dword v251, v250, s[28:29]
Lskip_1001:
  s_mov_b64 exec, -1
  s_mov_b32 s10, 4194304
  s_mov_b32 s11, 0x20000
  s_mov_b32 s22, 8388608
  s_mov_b32 s23, 0x20000
  v_lshrrev_b32 v7, 6, v0
  v_and_b32 v1, 63, v0
  v_readfirstlane_b32 s3, v7
  v_and_b32 v2, 15, v0
  v_bfe_u32 v3, v0, 4, 2
  v_and_b32 v4, 31, v0
  s_and_b32 s28, s2, 7
  s_lshl_b32 s28, s28, 7
  s_bfe_u32 s29, s2, 0x40003
  s_lshl_b32 s30, s29, 3
  s_add_u32 s56, s28, s30
  s_add_u32 s28, s56, s3
  s_lshl_b32 s30, s28, 8
  s_lshl_b32 s28, s28, 1
  v_lshl_add_u32 v7, v1, 2, s30
  v_mov_b32 v8, s28
  v_and_b32 v9, 0xff, v0
  s_lshl_b32 s28, s56, 1
  v_lshl_add_u32 v252, v9, 13, s28
  s_mov_b32 s59, 0x200000
  s_mov_b32 s36, 0x1000
  s_mov_b32 s37, 0x201000
  s_waitcnt lgkmcnt(0)
  global_load_short_d16_hi v38, v8, s[52:53]
  global_load_dword v32, v7, s[40:41]
  global_load_dword v33, v7, s[42:43]
  global_load_dword v34, v7, s[44:45]
  global_load_dword v35, v7, s[46:47]
  global_load_dword v36, v7, s[48:49]
  global_load_dword v37, v7, s[50:51]
  global_load_short_d16_hi v249, v8, s[54:55]
  s_branch L_B_body
L_A:
  s_load_dwordx2 s[8:9], s[0:1], 0
  s_load_dwordx2 s[24:25], s[0:1], 112
  s_load_dwordx2 s[12:13], s[0:1], 8
  s_load_dwordx2 s[16:17], s[0:1], 16
  s_load_dwordx2 s[20:21], s[0:1], 96
  s_getpc_b64 s[28:29]
Lpc_1:
  v_lshlrev_b32 v250, 7, v0
  v_cmp_gt_u32 vcc, (L_A_end-Lpc_1-4), v250
  s_nop 0
  s_and_saveexec_b64 s[30:31], vcc
  s_cbranch_execz Lskip_2
  global_load_dword v251, v250, s[28:29]
Lskip_2:
  s_mov_b64 exec, -1
  s_mov_b32 s47, 0x07060302
  s_mov_b32 s10, 4194304
  s_mov_b32 s11, 0x20000
  s_mov_b32 s26, 268435456
  s_mov_b32 s27, 0x20000
  s_mov_b32 s14, 2101248
  s_mov_b32 s15, 0x20000
  s_mov_b32 s18, 2101248
  s_mov_b32 s19, 0x20000
  s_mov_b32 s22, 8388608
  s_mov_b32 s23, 0x20000
  v_lshrrev_b32 v4, 6, v0
  v_and_b32 v3, 63, v0
  v_readfirstlane_b32 s3, v4
  v_and_b32 v1, 15, v0
  v_bfe_u32 v2, v0, 4, 2
  s_lshl_b32 s48, s2, 11
  s_add_u32 s49, s48, 262144
  s_add_u32 s50, s48, 524288
  s_add_u32 s51, s48, 786432
  v_lshlrev_b32 v224, 20, v2
  v_lshl_or_b32 v224, v1, 4, v224
  v_lshl_or_b32 v224, v4, 8, v224
  s_waitcnt lgkmcnt(0)
  buffer_load_dwordx4 v[16:19], v224, s[8:11], s48 offen
  buffer_load_dwordx4 v[20:23], v224, s[8:11], s49 offen
  buffer_load_dwordx4 v[24:27], v224, s[8:11], s50 offen
  buffer_load_dwordx4 v[28:31], v224, s[8:11], s51 offen
  s_and_b32 s41, s2, 7
  s_lshr_b32 s42, s2, 3
  s_lshl_b32 s43, s41, 12
  s_mov_b32 s44, 2048
  s_mov_b32 s46, 0
  s_cmp_lg_u32 s41, 0
  s_cbranch_scc1 Lskip_3
  s_and_b32 s41, s42, 8
  s_lshl_b32 s43, s41, 8
  s_and_b32 s42, s42, 7
  s_mov_b32 s44, 1024
  s_mov_b32 s46, 1
Lskip_3:
  s_lshl_b32 s28, s42, 7
  s_add_u32 s43, s43, s28
  v_cvt_f32_u32 v248, v1
  v_cvt_f32_u32 v249, v2
  v_lshrrev_b32 v4, 1, v1
  v_cmp_eq_u32 vcc, 1, v1
  s_nop 1
  v_cndmask_b32 v4, v4, 8, vcc
  v_cvt_f32_u32 v4, v4
  v_and_b32 v5, 1, v1
  v_lshlrev_b32 v5, 31, v5
  v_cndmask_b32 v252, v5, 0, vcc
  v_mul_f32 v5, 0x3e800000, v249
  v_mul_f32 v32, v4, v5
  v_fmamk_f32 v35, v4, 0x3e400000, v32
  v_fmamk_f32 v34, v4, 0x3e000000, v32
  v_fmamk_f32 v33, v4, 0x3d800000, v32
  v_cos_f32 v48, v32
  v_sin_f32 v49, v32
  v_cos_f32 v50, v33
  v_sin_f32 v51, v33
  v_cos_f32 v52, v34
  v_sin_f32 v53, v34
  v_cos_f32 v54, v35
  v_sin_f32 v55, v35
  v_cvt_pk_bf16_f32 v80, v48, v49
  v_cvt_pk_bf16_f32 v84, -v49, v48
  v_cvt_pk_bf16_f32 v81, v50, v51
  v_cvt_pk_bf16_f32 v85, -v51, v50
  v_cvt_pk_bf16_f32 v82, v52, v53
  v_cvt_pk_bf16_f32 v86, -v53, v52
  v_cvt_pk_bf16_f32 v83, v54, v55
  v_cvt_pk_bf16_f32 v87, -v55, v54
  v_xor_b32 v80, v252, v80
  v_xor_b32 v81, v252, v81
  v_xor_b32 v82, v252, v82
  v_xor_b32 v83, v252, v83
  v_xor_b32 v84, v252, v84
  v_xor_b32 v85, v252, v85
  v_xor_b32 v86, v252, v86
  v_xor_b32 v87, v252, v87
  v_mul_f32 v32, v248, v5
  v_fmamk_f32 v35, v248, 0x3e400000, v32
  v_fmamk_f32 v34, v248, 0x3e000000, v32
  v_fmamk_f32 v33, v248, 0x3d800000, v32
  v_cos_f32 v48, v32
  v_sin_f32 v49, v32
  v_cos_f32 v50, v33
  v_sin_f32 v51, v33
  v_cos_f32 v52, v34
  v_sin_f32 v53, v34
  v_cos_f32 v54, v35
  v_sin_f32 v55, v35
  v_cvt_pk_bf16_f32 v88, v48, v49
  v_cvt_pk_bf16_f32 v92, -v49, v48
  v_cvt_pk_bf16_f32 v89, v50, v51
  v_cvt_pk_bf16_f32 v93, -v51, v50
  v_cvt_pk_bf16_f32 v90, v52, v53
  v_cvt_pk_bf16_f32 v94, -v53, v52
  v_cvt_pk_bf16_f32 v91, v54, v55
  v_cvt_pk_bf16_f32 v95, -v55, v54
  v_mul_f32 v6, 0x3c800000, v249
  v_mul_f32 v32, v248, v6
  v_fmamk_f32 v36, v248, 0x3b000000, v32
  v_fmamk_f32 v35, v248, 0x3c400000, v32
  v_fmamk_f32 v34, v248, 0x3c000000, v32
  v_fmamk_f32 v33, v248, 0x3b800000, v32
  v_fmamk_f32 v39, v248, 0x3c400000, v36
  v_fmamk_f32 v38, v248, 0x3c000000, v36
  v_fmamk_f32 v37, v248, 0x3b800000, v36
  v_cos_f32 v96, v32
  v_sin_f32 v97, v32
  v_cos_f32 v98, v33
  v_sin_f32 v99, v33
  v_cos_f32 v100, v34
  v_sin_f32 v101, v34
  v_cos_f32 v102, v35
  v_sin_f32 v103, v35
  v_cos_f32 v104, v36
  v_sin_f32 v105, v36
  v_cos_f32 v106, v37
  v_sin_f32 v107, v37
  v_cos_f32 v108, v38
  v_sin_f32 v109, v38
  v_cos_f32 v110, v39
  v_sin_f32 v111, v39
  v_mul_f32 v32, v248, v5
  v_fmamk_f32 v36, v248, 0x3d000000, v32
  v_fmamk_f32 v35, v248, 0x3e400000, v32
  v_fmamk_f32 v34, v248, 0x3e000000, v32
  v_fmamk_f32 v33, v248, 0x3d800000, v32
  v_fmamk_f32 v39, v248, 0x3e400000, v36
  v_fmamk_f32 v38, v248, 0x3e000000, v36
  v_fmamk_f32 v37, v248, 0x3d800000, v36
  v_cos_f32 v48, v32
  v_sin_f32 v49, v32
  v_cos_f32 v50, v33
  v_sin_f32 v51, v33
  v_cos_f32 v52, v34
  v_sin_f32 v53, v34
  v_cos_f32 v54, v35
  v_sin_f32 v55, v35
  v_cvt_pk_bf16_f32 v112, v48, v49
  v_cvt_pk_bf16_f32 v116, -v49, v48
  v_cvt_pk_bf16_f32 v113, v50, v51
  v_cvt_pk_bf16_f32 v117, -v51, v50
  v_cvt_pk_bf16_f32 v114, v52, v53
  v_cvt_pk_bf16_f32 v118, -v53, v52
  v_cvt_pk_bf16_f32 v115, v54, v55
  v_cvt_pk_bf16_f32 v119, -v55, v54
  v_cos_f32 v56, v36
  v_sin_f32 v57, v36
  v_cos_f32 v58, v37
  v_sin_f32 v59, v37
  v_cos_f32 v60, v38
  v_sin_f32 v61, v38
  v_cos_f32 v62, v39
  v_sin_f32 v63, v39
  v_cvt_pk_bf16_f32 v120, v56, v57
  v_cvt_pk_bf16_f32 v124, -v57, v56
  v_cvt_pk_bf16_f32 v121, v58, v59
  v_cvt_pk_bf16_f32 v125, -v59, v58
  v_cvt_pk_bf16_f32 v122, v60, v61
  v_cvt_pk_bf16_f32 v126, -v61, v60
  v_cvt_pk_bf16_f32 v123, v62, v63
  v_cvt_pk_bf16_f32 v127, -v63, v62
  v_xor_b32 v128, 0x80008000, v120
  v_xor_b32 v129, 0x80008000, v121
  v_xor_b32 v130, 0x80008000, v122
  v_xor_b32 v131, 0x80008000, v123
  v_xor_b32 v132, 0x80008000, v124
  v_xor_b32 v133, 0x80008000, v125
  v_xor_b32 v134, 0x80008000, v126
  v_xor_b32 v135, 0x80008000, v127
  v_lshrrev_b32 v4, 3, v1
  v_mul_u32_u24 v4, 144, v4
  v_and_b32 v5, 7, v1
  v_lshl_add_u32 v4, v5, 3, v4
  s_mul_i32 s28, s3, 288
  v_mul_u32_u24 v225, 9216, v2
  v_add3_u32 v225, v225, v4, s28
  s_mul_i32 s28, s3, 4608
  v_mul_u32_u24 v4, 576, v2
  v_lshl_add_u32 v4, v1, 2, v4
  v_add_u32 v226, s28, v4
  v_add_u32 v244, 2304, v226
  s_and_b32 s28, s2, 7
  s_cselect_b32 s29, s28, 8
  s_and_b32 s30, s2, 0x78
  v_bfe_u32 v12, v0, 4, 3
  v_add_u32 v12, s30, v12
  v_lshlrev_b32 v12, 4, v12
  v_add_u32 v13, s29, v12
  v_add_u32 v12, s28, v12
  v_sub_u32 v13, 0, v13
  v_and_b32 v13, 0x7ff, v13
  s_bitcmp1_b32 s3, 1
  s_cselect_b64 vcc, -1, 0
  v_cndmask_b32 v12, v12, v13, vcc
  v_mul_u32_u24 v12, 1026, v12
  v_lshl_add_u32 v12, v1, 7, v12
  v_cmp_gt_u32 vcc, 9, v1
  v_mov_b32 v203, 0x7ffffff0
  s_nop 0
  v_cndmask_b32 v203, v203, v12, vcc
  s_lshl_b32 s28, s2, 8
  s_mul_i32 s29, s3, 32896
  s_add_u32 s29, s29, s28
  v_and_b32 v4, 56, v3
  v_and_b32 v5, 7, v3
  v_lshlrev_b32 v5, 4, v5
  v_mul_u32_u24 v4, 32896, v4
  v_add_u32 v4, v4, v5
  v_add_u32 v227, s29, v4
  s_mov_b32 s59, 2105344
  v_sub_u32 v4, 16, v1
  v_and_b32 v5, 7, v4
  v_bfe_u32 v4, v4, 3, 1
  v_sub_u32 v6, 3, v2
  v_lshl_add_u32 v4, v6, 1, v4
  v_lshlrev_b32 v5, 4, v5
  v_mul_u32_u24 v4, 263168, v4
  v_add_u32 v4, v4, v5
  v_add_u32 v253, s28, v4
  v_add_u32 v4, 16, v3
  v_and_b32 v4, 63, v4
  v_lshlrev_b32 v254, 2, v4
  v_lshrrev_b32 v4, 2, v0
  v_lshl_add_u32 v4, v4, 4, s41
  v_sub_u32 v5, 0, v4
  v_and_b32 v5, 0x7ff, v5
  v_and_b32 v6, 3, v0
  v_lshlrev_b32 v6, 5, v6
  v_sub_u32 v7, 96, v6
  s_movk_i32 s28, 1026
  v_mad_u32_u24 v242, v4, s28, v6
  v_mad_u32_u24 v243, v5, s28, v7
  s_lshr_b32 s58, s42, 1
  s_lshl_b32 s58, s58, 3
  s_and_b32 s28, s42, 1
  s_add_u32 s58, s58, s28
  s_lshl_b32 s58, s58, 3
  s_lshl_b32 s56, s58, 1
  s_sub_u32 s57, 914, s56
  v_and_b32 v6, 3, v0
  v_mul_u32_u24 v4, 1026, v4
  v_mul_u32_u24 v5, 1026, v5
  v_lshlrev_b32 v7, 9, v6
  v_sub_u32 v7, 1536, v7
  v_add_u32 v4, v4, v7
  v_cmp_eq_u32 vcc, 0, v6
  s_add_u32 s28, s46, 2
  s_cmp_eq_u32 s42, 0
  s_cselect_b32 s28, s28, 0
  v_cndmask_b32 v4, v4, v5, vcc
  v_cmp_gt_u32 vcc, s28, v6
  v_mov_b32 v5, 0x7ffffff0
  s_nop 0
  v_cndmask_b32 v255, v5, v4, vcc
  s_waitcnt vmcnt(2)
  v_pk_mov_b32 v[32:33], v[16:17], v[20:21] op_sel:[0,0]
  s_waitcnt vmcnt(0)
  v_pk_mov_b32 v[34:35], v[24:25], v[28:29] op_sel:[0,0]
  v_pk_mov_b32 v[36:37], v[16:17], v[20:21] op_sel:[1,1]
  v_pk_mov_b32 v[38:39], v[24:25], v[28:29] op_sel:[1,1]
  v_pk_mov_b32 v[40:41], v[18:19], v[22:23] op_sel:[0,0]
  v_pk_mov_b32 v[42:43], v[26:27], v[30:31] op_sel:[0,0]
  v_pk_mov_b32 v[44:45], v[18:19], v[22:23] op_sel:[1,1]
  v_pk_mov_b32 v[46:47], v[26:27], v[30:31] op_sel:[1,1]
  s_cmp_lg_u32 s3, 0
  s_cbranch_scc1 Lskip_4
  s_mov_b32 s28, 11010048
  s_mov_b64 exec, 1
  buffer_load_dword v229, off, s[24:27], s28 sc1
  s_mov_b64 exec, -1
Lskip_4:
  s_cmp_lg_u32 s3, 0
  s_cbranch_scc1 Lskip_5
  s_mul_i32 s28, s2, 128
  s_add_u32 s28, s28, 10485760
  v_lshrrev_b32 v11, 3, v3
  v_mul_u32_u24 v11, 16256, v11
  v_lshl_add_u32 v11, v3, 4, v11
  s_add_u32 s29, s28, 262144
  v_mov_b32 v12, 0
  v_mov_b32 v13, 0
  v_mov_b32 v14, 0
  v_mov_b32 v15, 0
  s_mov_b32 exec_lo, 0xff
  s_mov_b32 exec_hi, 0
  buffer_store_dwordx4 v[12:15], v11, s[24:27], s28 offen sc1
  buffer_store_dwordx4 v[12:15], v11, s[24:27], s29 offen sc1
  s_mov_b64 exec, -1
Lskip_5:
  v_mfma_f32_16x16x32_bf16 v[48:51], v[80:83], v[32:35], 0
  v_mfma_f32_16x16x32_bf16 v[52:55], v[84:87], v[32:35], 0
  v_mfma_f32_16x16x32_bf16 v[64:67], v[80:83], v[40:43], 0
  v_mfma_f32_16x16x32_bf16 v[68:71], v[84:87], v[40:43], 0
  v_mfma_f32_16x16x32_bf16 v[56:59], v[80:83], v[36:39], 0
  v_mfma_f32_16x16x32_bf16 v[60:63], v[84:87], v[36:39], 0
  v_mfma_f32_16x16x32_bf16 v[72:75], v[80:83], v[44:47], 0
  v_mfma_f32_16x16x32_bf16 v[76:79], v[84:87], v[44:47], 0
  s_cmp_gt_u32 s3, 3
  s_cbranch_scc1 Lelse_6
  buffer_load_dword v205, v203, s[12:15], 0 offen
  s_branch Lend_7
Lelse_6:
  buffer_load_dword v205, v203, s[16:19], 0 offen
Lend_7:
  v_cvt_pk_bf16_f32 v16, v48, v52
  v_cvt_pk_bf16_f32 v17, v64, v68
  ds_write_b64 v225, v[16:17] offset:0
  v_cvt_pk_bf16_f32 v18, v49, v53
  v_cvt_pk_bf16_f32 v19, v65, v69
  ds_write_b64 v225, v[18:19] offset:2304
  v_cvt_pk_bf16_f32 v20, v50, v54
  v_cvt_pk_bf16_f32 v21, v66, v70
  ds_write_b64 v225, v[20:21] offset:4608
  v_cvt_pk_bf16_f32 v22, v51, v55
  v_cvt_pk_bf16_f32 v23, v67, v71
  ds_write_b64 v225, v[22:23] offset:6912
  v_cvt_pk_bf16_f32 v24, v56, v60
  v_cvt_pk_bf16_f32 v25, v72, v76
  ds_write_b64 v225, v[24:25] offset:64
  v_cvt_pk_bf16_f32 v26, v57, v61
  v_cvt_pk_bf16_f32 v27, v73, v77
  ds_write_b64 v225, v[26:27] offset:2368
  v_cvt_pk_bf16_f32 v28, v58, v62
  v_cvt_pk_bf16_f32 v29, v74, v78
  ds_write_b64 v225, v[28:29] offset:4672
  v_cvt_pk_bf16_f32 v30, v59, v63
  v_cvt_pk_bf16_f32 v31, v75, v79
  ds_write_b64 v225, v[30:31] offset:6976
  s_waitcnt lgkmcnt(0)
  s_barrier
  ds_read2_b32 v[32:33], v226 offset0:0 offset1:36
  ds_read2_b32 v[34:35], v226 offset0:72 offset1:108
  ds_read2_b32 v[36:37], v226 offset0:16 offset1:52
  ds_read2_b32 v[38:39], v226 offset0:88 offset1:124
  ds_read2_b32 v[40:41], v244 offset0:0 offset1:36
  ds_read2_b32 v[42:43], v244 offset0:72 offset1:108
  ds_read2_b32 v[44:45], v244 offset0:16 offset1:52
  ds_read2_b32 v[46:47], v244 offset0:88 offset1:124
  s_waitcnt lgkmcnt(6)
  v_mfma_f32_16x16x32_bf16 v[48:51], v[32:35], v[88:91], 0
  v_mfma_f32_16x16x32_bf16 v[52:55], v[32:35], v[92:95], 0
  s_waitcnt lgkmcnt(4)
  v_mfma_f32_16x16x32_bf16 v[56:59], v[36:39], v[88:91], 0
  v_mfma_f32_16x16x32_bf16 v[60:63], v[36:39], v[92:95], 0
  s_waitcnt lgkmcnt(2)
  v_mfma_f32_16x16x32_bf16 v[64:67], v[40:43], v[88:91], 0
  v_mfma_f32_16x16x32_bf16 v[68:71], v[40:43], v[92:95], 0
  s_waitcnt lgkmcnt(0)
  v_mfma_f32_16x16x32_bf16 v[72:75], v[44:47], v[88:91], 0
  v_mfma_f32_16x16x32_bf16 v[76:79], v[44:47], v[92:95], 0
  v_mul_f32 v4, v48, v96
  v_mul_f32 v5, v52, v96
  v_mul_f32 v6, v49, v98
  v_mul_f32 v7, v53, v98
  v_mul_f32 v8, v50, v100
  v_mul_f32 v9, v54, v100
  v_mul_f32 v10, v51, v102
  v_mul_f32 v11, v55, v102
  v_fmac_f32 v4, v52, v97
  v_fma_f32 v5, -v48, v97, v5
  v_fmac_f32 v6, v53, v99
  v_fma_f32 v7, -v49, v99, v7
  v_fmac_f32 v8, v54, v101
  v_fma_f32 v9, -v50, v101, v9
  v_fmac_f32 v10, v55, v103
  v_fma_f32 v11, -v51, v103, v11
  v_perm_b32 v32, v5, v4, s47
  v_perm_b32 v33, v7, v6, s47
  v_perm_b32 v34, v9, v8, s47
  v_perm_b32 v35, v11, v10, s47
  v_mul_f32 v4, v56, v104
  v_mul_f32 v5, v60, v104
  v_mul_f32 v6, v57, v106
  v_mul_f32 v7, v61, v106
  v_mul_f32 v8, v58, v108
  v_mul_f32 v9, v62, v108
  v_mul_f32 v10, v59, v110
  v_mul_f32 v11, v63, v110
  v_fmac_f32 v4, v60, v105
  v_fma_f32 v5, -v56, v105, v5
  v_fmac_f32 v6, v61, v107
  v_fma_f32 v7, -v57, v107, v7
  v_fmac_f32 v8, v62, v109
  v_fma_f32 v9, -v58, v109, v9
  v_fmac_f32 v10, v63, v111
  v_fma_f32 v11, -v59, v111, v11
  v_perm_b32 v36, v5, v4, s47
  v_perm_b32 v37, v7, v6, s47
  v_perm_b32 v38, v9, v8, s47
  v_perm_b32 v39, v11, v10, s47
  v_mul_f32 v4, v64, v96
  v_mul_f32 v5, v68, v96
  v_mul_f32 v6, v65, v98
  v_mul_f32 v7, v69, v98
  v_mul_f32 v8, v66, v100
  v_mul_f32 v9, v70, v100
  v_mul_f32 v10, v67, v102
  v_mul_f32 v11, v71, v102
  v_fmac_f32 v4, v68, v97
  v_fma_f32 v5, -v64, v97, v5
  v_fmac_f32 v6, v69, v99
  v_fma_f32 v7, -v65, v99, v7
  v_fmac_f32 v8, v70, v101
  v_fma_f32 v9, -v66, v101, v9
  v_fmac_f32 v10, v71, v103
  v_fma_f32 v11, -v67, v103, v11
  v_perm_b32 v40, v5, v4, s47
  v_perm_b32 v41, v7, v6, s47
  v_perm_b32 v42, v9, v8, s47
  v_perm_b32 v43, v11, v10, s47
  v_mul_f32 v4, v72, v104
  v_mul_f32 v5, v76, v104
  v_mul_f32 v6, v73, v106
  v_mul_f32 v7, v77, v106
  v_mul_f32 v8, v74, v108
  v_mul_f32 v9, v78, v108
  v_mul_f32 v10, v75, v110
  v_mul_f32 v11, v79, v110
  v_fmac_f32 v4, v76, v105
  v_fma_f32 v5, -v72, v105, v5
  v_fmac_f32 v6, v77, v107
  v_fma_f32 v7, -v73, v107, v7
  v_fmac_f32 v8, v78, v109
  v_fma_f32 v9, -v74, v109, v9
  v_fmac_f32 v10, v79, v111
  v_fma_f32 v11, -v75, v111, v11
  v_perm_b32 v44, v5, v4, s47
  v_perm_b32 v45, v7, v6, s47
  v_perm_b32 v46, v9, v8, s47
  v_perm_b32 v47, v11, v10, s47
  v_mfma_f32_16x16x32_bf16 v[48:51], v[112:115], v[32:35], 0
  v_mfma_f32_16x16x32_bf16 v[52:55], v[116:119], v[32:35], 0
  v_mfma_f32_16x16x32_bf16 v[48:51], v[120:123], v[36:39], v[48:51]
  v_mfma_f32_16x16x32_bf16 v[52:55], v[124:127], v[36:39], v[52:55]
  v_mfma_f32_16x16x32_bf16 v[64:67], v[112:115], v[40:43], 0
  v_mfma_f32_16x16x32_bf16 v[68:71], v[116:119], v[40:43], 0
  v_mfma_f32_16x16x32_bf16 v[64:67], v[120:123], v[44:47], v[64:67]
  v_mfma_f32_16x16x32_bf16 v[68:71], v[124:127], v[44:47], v[68:71]
  v_mfma_f32_16x16x32_bf16 v[56:59], v[112:115], v[32:35], 0
  v_mfma_f32_16x16x32_bf16 v[60:63], v[116:119], v[32:35], 0
  v_mfma_f32_16x16x32_bf16 v[56:59], v[128:131], v[36:39], v[56:59]
  v_mfma_f32_16x16x32_bf16 v[60:63], v[132:135], v[36:39], v[60:63]
  v_perm_b32 v16, v52, v48, s47
  v_perm_b32 v17, v53, v49, s47
  v_perm_b32 v18, v54, v50, s47
  v_perm_b32 v19, v55, v51, s47
  buffer_store_dwordx4 v[16:19], v227, s[24:27], 0 offen offset:0 sc1
  v_mfma_f32_16x16x32_bf16 v[72:75], v[112:115], v[40:43], 0
  v_mfma_f32_16x16x32_bf16 v[76:79], v[116:119], v[40:43], 0
  v_mfma_f32_16x16x32_bf16 v[72:75], v[128:131], v[44:47], v[72:75]
  v_mfma_f32_16x16x32_bf16 v[76:79], v[132:135], v[44:47], v[76:79]
  s_cmp_eq_u32 s3, 0
  s_cbranch_scc1 Lelse_8
  v_perm_b32 v24, v68, v64, s47
  v_perm_b32 v25, v69, v65, s47
  v_perm_b32 v26, v70, v66, s47
  v_perm_b32 v27, v71, v67, s47
  buffer_store_dwordx4 v[24:27], v227, s[24:27], 0 offen offset:128 sc1
  v_perm_b32 v20, v60, v56, s47
  v_perm_b32 v21, v61, v57, s47
  v_perm_b32 v22, v62, v58, s47
  v_perm_b32 v23, v63, v59, s47
  buffer_store_dwordx4 v[20:23], v227, s[24:27], s59 offen offset:0 sc1
  v_perm_b32 v28, v76, v72, s47
  v_perm_b32 v29, v77, v73, s47
  v_perm_b32 v30, v78, v74, s47
  v_perm_b32 v31, v79, v75, s47
  buffer_store_dwordx4 v[28:31], v227, s[24:27], s59 offen offset:128 sc1
  s_branch Lend_9
Lelse_8:
  v_cmp_eq_u32 vcc, 0, v1
  v_perm_b32 v24, v68, v64, s47
  v_perm_b32 v25, v69, v65, s47
  v_perm_b32 v26, v70, v66, s47
  v_perm_b32 v27, v71, v67, s47
  buffer_store_dwordx4 v[24:27], v227, s[24:27], s59 offen offset:0 sc1
  v_perm_b32 v4, v60, v56, s47
  v_xor_b32 v4, 0x80000000, v4
  ds_bpermute_b32 v8, v254, v4
  v_perm_b32 v5, v61, v57, s47
  v_xor_b32 v5, 0x80000000, v5
  v_perm_b32 v6, v62, v58, s47
  v_xor_b32 v6, 0x80000000, v6
  v_perm_b32 v7, v63, v59, s47
  v_xor_b32 v7, 0x80000000, v7
  v_perm_b32 v9, v76, v72, s47
  v_xor_b32 v9, 0x80000000, v9
  ds_bpermute_b32 v13, v254, v9
  v_perm_b32 v10, v77, v73, s47
  v_xor_b32 v10, 0x80000000, v10
  v_perm_b32 v11, v78, v74, s47
  v_xor_b32 v11, 0x80000000, v11
  v_perm_b32 v12, v79, v75, s47
  v_xor_b32 v12, 0x80000000, v12
  v_cndmask_b32 v23, v4, v5, vcc
  v_cndmask_b32 v22, v5, v6, vcc
  v_cndmask_b32 v21, v6, v7, vcc
  s_waitcnt lgkmcnt(1)
  v_cndmask_b32 v20, v7, v8, vcc
  buffer_store_dwordx4 v[20:23], v253, s[24:27], 0 offen offset:128 sc1
  v_cndmask_b32 v31, v9, v10, vcc
  v_cndmask_b32 v30, v10, v11, vcc
  v_cndmask_b32 v29, v11, v12, vcc
  s_waitcnt lgkmcnt(0)
  v_cndmask_b32 v28, v12, v13, vcc
  buffer_store_dwordx4 v[28:31], v253, s[24:27], s59 offen offset:128 sc1
Lend_9:
  s_barrier
  buffer_load_dwordx4 v[208:211], v242, s[12:15], s56 offen
  buffer_load_dwordx4 v[212:215], v242, s[16:19], s56 offen
  s_mul_i32 s45, s2, 128
  s_add_u32 s45, s45, 10485760
  v_mul_u32_u24 v250, 16384, v3
  v_mov_b32 v244, 0
  v_mov_b32 v245, 0
  v_mov_b32 v246, 0
  v_mov_b32 v247, 0
  v_lshlrev_b32 v202, 4, v3
  v_add_u32 v202, 139072, v202
  v_cvt_f32_u32 v6, s41
  v_mul_f32 v6, 0x3d800000, v6
  v_add_f32 v4, v248, v6
  v_and_b32 v5, 1, v2
  v_lshlrev_b32 v5, 2, v5
  v_cvt_f32_u32 v5, v5
  v_and_b32 v8, 7, v1
  v_cvt_f32_u32 v8, v8
  v_lshrrev_b32 v9, 3, v1
  v_lshrrev_b32 v10, 1, v2
  v_fmamk_f32 v7, v249, 0x40800000, v6
  s_cmp_lg_u32 s3, 1
  s_cbranch_scc1 Lskip_10
  v_mul_f32 v11, 0x3e800000, v249
  v_mul_f32 v16, v4, v11
  v_fmamk_f32 v19, v4, 0x3e400000, v16
  v_fmamk_f32 v18, v4, 0x3e000000, v16
  v_fmamk_f32 v17, v4, 0x3d800000, v16
  v_cos_f32 v48, v16
  v_sin_f32 v49, v16
  v_cos_f32 v50, v17
  v_sin_f32 v51, v17
  v_cos_f32 v52, v18
  v_sin_f32 v53, v18
  v_cos_f32 v54, v19
  v_sin_f32 v55, v19
  v_cvt_pk_bf16_f32 v136, v48, v49
  v_cvt_pk_bf16_f32 v140, -v49, v48
  v_cvt_pk_bf16_f32 v137, v50, v51
  v_cvt_pk_bf16_f32 v141, -v51, v50
  v_cvt_pk_bf16_f32 v138, v52, v53
  v_cvt_pk_bf16_f32 v142, -v53, v52
  v_cvt_pk_bf16_f32 v139, v54, v55
  v_cvt_pk_bf16_f32 v143, -v55, v54
  ds_write_b128 v202, v[136:139] offset:0
  ds_write_b128 v202, v[140:143] offset:1024
Lskip_10:
  s_cmp_lg_u32 s3, 2
  s_cbranch_scc1 Lskip_11
  v_mul_f32 v11, 0x3c000000, v5
  v_mul_f32 v16, v4, v11
  v_fmamk_f32 v19, v4, 0x3cc00000, v16
  v_fmamk_f32 v18, v4, 0x3c800000, v16
  v_fmamk_f32 v17, v4, 0x3c000000, v16
  v_cos_f32 v144, v16
  v_sin_f32 v145, v16
  v_cos_f32 v146, v17
  v_sin_f32 v147, v17
  v_cos_f32 v148, v18
  v_sin_f32 v149, v18
  v_cos_f32 v150, v19
  v_sin_f32 v151, v19
  v_mul_f32 v144, 0x3f811600, v144
  v_mul_f32 v145, 0x3f811600, v145
  v_mul_f32 v146, 0x3f811600, v146
  v_mul_f32 v147, 0x3f811600, v147
  v_mul_f32 v148, 0x3f811600, v148
  v_mul_f32 v149, 0x3f811600, v149
  v_mul_f32 v150, 0x3f811600, v150
  v_mul_f32 v151, 0x3f811600, v151
  ds_write_b128 v202, v[144:147] offset:2048
  ds_write_b128 v202, v[148:151] offset:3072
Lskip_11:
  s_cmp_lg_u32 s3, 3
  s_cbranch_scc1 Lskip_12
  v_mul_f32 v11, 0x3e000000, v5
  v_mul_f32 v16, v8, v11
  v_fmamk_f32 v19, v8, 0x3ec00000, v16
  v_fmamk_f32 v18, v8, 0x3e800000, v16
  v_fmamk_f32 v17, v8, 0x3e000000, v16
  v_cos_f32 v48, v16
  v_sin_f32 v49, v16
  v_cos_f32 v50, v17
  v_sin_f32 v51, v17
  v_cos_f32 v52, v18
  v_sin_f32 v53, v18
  v_cos_f32 v54, v19
  v_sin_f32 v55, v19
  v_cvt_pk_bf16_f32 v152, v48, v49
  v_cvt_pk_bf16_f32 v156, -v49, v48
  v_cvt_pk_bf16_f32 v153, v50, v51
  v_cvt_pk_bf16_f32 v157, -v51, v50
  v_cvt_pk_bf16_f32 v154, v52, v53
  v_cvt_pk_bf16_f32 v158, -v53, v52
  v_cvt_pk_bf16_f32 v155, v54, v55
  v_cvt_pk_bf16_f32 v159, -v55, v54
  v_cmp_eq_u32 vcc, v9, v10
  s_nop 1
  v_cndmask_b32 v152, 0, v152, vcc
  v_cndmask_b32 v153, 0, v153, vcc
  v_cndmask_b32 v154, 0, v154, vcc
  v_cndmask_b32 v155, 0, v155, vcc
  v_cndmask_b32 v156, 0, v156, vcc
  v_cndmask_b32 v157, 0, v157, vcc
  v_cndmask_b32 v158, 0, v158, vcc
  v_cndmask_b32 v159, 0, v159, vcc
  ds_write_b128 v202, v[152:155] offset:4096
  ds_write_b128 v202, v[156:159] offset:5120
Lskip_12:
  s_cmp_lg_u32 s3, 4
  s_cbranch_scc1 Lskip_13
  v_mul_f32 v11, 0x3c000000, v7
  v_mul_f32 v16, v8, v11
  v_fmamk_f32 v19, v8, 0x3cc00000, v16
  v_fmamk_f32 v18, v8, 0x3c800000, v16
  v_fmamk_f32 v17, v8, 0x3c000000, v16
  v_cos_f32 v160, v16
  v_sin_f32 v161, v16
  v_cos_f32 v162, v17
  v_sin_f32 v163, v17
  v_cos_f32 v164, v18
  v_sin_f32 v165, v18
  v_cos_f32 v166, v19
  v_sin_f32 v167, v19
  v_mul_f32 v160, 0x3f80b912, v160
  v_mul_f32 v161, 0x3f80b912, v161
  v_mul_f32 v162, 0x3f80b912, v162
  v_mul_f32 v163, 0x3f80b912, v163
  v_mul_f32 v164, 0x3f80b912, v164
  v_mul_f32 v165, 0x3f80b912, v165
  v_mul_f32 v166, 0x3f80b912, v166
  v_mul_f32 v167, 0x3f80b912, v167
  ds_write_b128 v202, v[160:163] offset:6144
  ds_write_b128 v202, v[164:167] offset:7168
Lskip_13:
  s_cmp_lg_u32 s3, 6
  s_cbranch_scc1 Lskip_14
  v_mul_f32 v11, 0x3d800000, v7
  v_mul_f32 v16, v248, v11
  v_fmamk_f32 v19, v248, 0x3e400000, v16
  v_fmamk_f32 v18, v248, 0x3e000000, v16
  v_fmamk_f32 v17, v248, 0x3d800000, v16
  v_cos_f32 v48, v16
  v_sin_f32 v49, v16
  v_cos_f32 v50, v17
  v_sin_f32 v51, v17
  v_cos_f32 v52, v18
  v_sin_f32 v53, v18
  v_cos_f32 v54, v19
  v_sin_f32 v55, v19
  v_cvt_pk_bf16_f32 v168, v48, v49
  v_cvt_pk_bf16_f32 v172, -v49, v48
  v_cvt_pk_bf16_f32 v169, v50, v51
  v_cvt_pk_bf16_f32 v173, -v51, v50
  v_cvt_pk_bf16_f32 v170, v52, v53
  v_cvt_pk_bf16_f32 v174, -v53, v52
  v_cvt_pk_bf16_f32 v171, v54, v55
  v_cvt_pk_bf16_f32 v175, -v55, v54
  ds_write_b128 v202, v[168:171] offset:8192
  ds_write_b128 v202, v[172:175] offset:9216
Lskip_14:
  s_cmp_lg_u32 s3, 0
  s_cbranch_scc1 Lskip_15
  s_waitcnt vmcnt(4)
  v_readfirstlane_b32 s40, v229
  s_nop 0
  s_add_u32 s40, s40, 0x9e3779b9
  s_or_b32 s40, s40, 1
  v_mov_b32 v229, s40
  v_mov_b32 v15, 139008
  s_mov_b64 exec, 1
  ds_write_b32 v15, v229
  s_mov_b64 exec, -1
Lskip_15:
  s_waitcnt lgkmcnt(0)
  s_waitcnt vmcnt(2)
  s_barrier
  s_cmp_lg_u32 s3, 0
  s_cbranch_scc1 Lskip_16
  s_mov_b64 exec, 1
  buffer_store_dword v229, v250, s[24:27], s45 offen sc1
  s_mov_b64 exec, -1
Lskip_16:
  buffer_load_dwordx4 v[216:219], v243, s[12:15], s57 offen
  buffer_load_dwordx4 v[220:223], v243, s[16:19], s57 offen
  buffer_load_ushort v206, v255, s[12:15], 0 offen
  buffer_load_ushort v207, v255, s[16:19], 0 offen
  v_mov_b32 v229, 139008
  ds_read_b32 v229, v229
  v_bfe_u32 v4, v3, 3, 1
  v_mul_u32_u24 v4, s44, v4
  v_mul_u32_u24 v5, 32896, v2
  v_add_u32 v4, v4, v5
  v_add_u32 v4, s43, v4
  v_and_b32 v5, 7, v3
  v_lshl_add_u32 v241, v5, 4, v4
  v_lshrrev_b32 v4, 3, v3
  v_mul_u32_u24 v4, 32896, v4
  v_lshl_add_u32 v4, v5, 4, v4
  v_add_u32 v241, s43, v4
  v_and_b32 v4, 56, v3
  v_lshlrev_b32 v4, 4, v4
  v_xor_b32 v5, v5, v2
  v_lshl_add_u32 v230, v5, 4, v4
  v_xor_b32 v5, 4, v5
  v_lshl_add_u32 v231, v5, 4, v4
  v_and_b32 v4, 7, v1
  v_xor_b32 v5, s3, v4
  v_lshlrev_b32 v5, 4, v5
  v_lshl_or_b32 v5, v4, 8, v5
  v_lshl_or_b32 v5, v9, 3, v5
  v_mul_u32_u24 v6, 8196, v2
  v_add_u32 v5, v5, v6
  v_add_u32 v232, 36864, v5
  v_add_u32 v233, 36992, v5
  v_add_u32 v234, 36868, v5
  v_add_u32 v235, 36996, v5
  s_lshr_b32 s28, s3, 2
  s_lshl_b32 s28, s28, 4
  s_and_b32 s29, s3, 3
  s_lshl_b32 s29, s29, 5
  s_add_u32 s28, s28, s29
  s_lshl_b32 s28, s28, 2
  s_add_u32 s28, s28, 102656
  v_and_b32 v4, 3, v3
  v_mul_u32_u24 v4, 2080, v4
  v_and_b32 v5, 60, v3
  v_add3_u32 v236, v4, v5, s28
  v_and_b32 v4, 1, v2
  v_lshl_add_u32 v4, v4, 4, v1
  v_lshlrev_b32 v4, 2, v4
  v_mul_u32_u24 v5, 4160, v10
  v_add_u32 v5, v5, v4
  s_lshr_b32 s28, s3, 1
  s_mul_i32 s28, s28, 520
  s_and_b32 s29, s3, 1
  s_lshl_b32 s29, s29, 1
  s_add_u32 s28, s28, s29
  s_add_u32 s29, s28, 102656
  s_sub_u32 s30, 104218, s28
  v_add_u32 v237, s29, v5
  v_add_u32 v238, s30, v5
  v_and_b32 v4, 7, v1
  v_xor_b32 v5, s3, v4
  v_lshlrev_b32 v5, 4, v5
  v_lshl_or_b32 v5, v9, 3, v5
  v_and_b32 v6, 2, v1
  v_lshl_or_b32 v5, v6, 6, v5
  v_lshl_add_u32 v4, v2, 5, v4
  v_lshl_or_b32 v4, v4, 8, v5
  v_add_u32 v239, 69888, v4
  v_lshrrev_b32 v4, 3, v3
  v_xor_b32 v5, v4, v3
  v_and_b32 v5, 7, v5
  v_lshlrev_b32 v5, 4, v5
  v_and_b32 v6, 2, v4
  v_lshl_or_b32 v5, v6, 6, v5
  v_lshl_or_b32 v4, v4, 8, v5
  s_lshl_b32 s28, s3, 12
  s_add_u32 s28, s28, 69888
  v_add_u32 v240, s28, v4
  s_and_b32 s53, s2, 0
  s_lshl_b32 s53, s53, 7
  s_lshl_b32 s28, s3, 4
  s_add_u32 s28, s28, s53
  v_add_u32 v4, s28, v3
  v_mul_u32_u24 v228, 128, v4
  s_add_u32 s28, s58, s3
  v_lshl_add_u32 v4, v10, 5, s28
  v_cvt_f32_u32 v4, v4
  v_mul_f32 v4, 0x3a800000, v4
  v_add_f32 v5, 0x3c800000, v4
  v_sin_f32 v120, v4
  v_cos_f32 v121, v4
  v_sin_f32 v122, v5
  v_cos_f32 v123, v5
  v_mul_f32 v120, 0x35000493, v120
  v_mul_f32 v121, 0x35000493, v121
  v_mul_f32 v122, 0x35000493, v122
  v_mul_f32 v123, 0x35000493, v123
  ds_read_b128 v[136:139], v202 offset:0
  ds_read_b128 v[140:143], v202 offset:1024
  ds_read_b128 v[144:147], v202 offset:2048
  ds_read_b128 v[148:151], v202 offset:3072
  ds_read_b128 v[152:155], v202 offset:4096
  ds_read_b128 v[156:159], v202 offset:5120
  ds_read_b128 v[160:163], v202 offset:6144
  ds_read_b128 v[164:167], v202 offset:7168
  ds_read_b128 v[168:171], v202 offset:8192
  ds_read_b128 v[172:175], v202 offset:9216
  s_lshl_b32 s29, s3, 12
  s_lshl_b32 s30, s3, 1
  s_and_b32 s30, s30, 12
  s_mul_i32 s38, s2, 32896
  s_add_u32 s38, s38, s29
  s_add_u32 s29, s29, s30
  s_add_u32 s29, s29, 36864
  s_mov_b32 m0, s29
  s_waitcnt lgkmcnt(10)
  v_readfirstlane_b32 s40, v229
  s_waitcnt vmcnt(5)
  ds_write_b32 v236, v208 offset:0
  ds_write_b32 v236, v209 offset:520
  ds_write_b32 v236, v210 offset:1040
  ds_write_b32 v236, v211 offset:1560
  s_waitcnt vmcnt(4)
  ds_write_b32 v236, v212 offset:8320
  ds_write_b32 v236, v213 offset:8840
  ds_write_b32 v236, v214 offset:9360
  ds_write_b32 v236, v215 offset:9880
  s_waitcnt vmcnt(3)
  ds_write_b32 v236, v216 offset:16640
  ds_write_b32 v236, v217 offset:17160
  ds_write_b32 v236, v218 offset:17680
  ds_write_b32 v236, v219 offset:18200
  s_waitcnt vmcnt(2)
  ds_write_b32 v236, v220 offset:24960
  ds_write_b32 v236, v221 offset:25480
  ds_write_b32 v236, v222 offset:26000
  ds_write_b32 v236, v223 offset:26520
  s_waitcnt vmcnt(0)
  v_lshl_or_b32 v206, v207, 16, v206
  v_and_b32 v4, 3, v3
  v_mul_u32_u24 v4, 1568, v4
  v_sub_u32 v4, v236, v4
  ds_write_b32 v4, v206 offset:34304
  s_waitcnt lgkmcnt(0)
  s_barrier
  s_mov_b32 s52, 100000
  s_mov_b32 s39, 10485760
  s_mov_b64 exec, 0xffff
  buffer_load_dword v245, v228, s[24:27], s39 offen sc1
  s_mov_b64 exec, -1
  ds_read_u16_d16_hi v64, v237 offset:2080
  ds_read_u16_d16_hi v65, v237 offset:10400
  ds_read_u16_d16_hi v66, v238 offset:18720
  ds_read_u16_d16_hi v67, v238 offset:27040
  ds_read_u16_d16_hi v68, v237 offset:2208
  ds_read_u16_d16_hi v69, v237 offset:10528
  ds_read_u16_d16_hi v70, v238 offset:18848
  ds_read_u16_d16_hi v71, v238 offset:27168
  ds_read_u16_d16_hi v72, v237 offset:2336
  ds_read_u16_d16_hi v73, v237 offset:10656
  ds_read_u16_d16_hi v74, v238 offset:18976
  ds_read_u16_d16_hi v75, v238 offset:27296
  ds_read_u16_d16_hi v76, v237 offset:2464
  ds_read_u16_d16_hi v77, v237 offset:10784
  ds_read_u16_d16_hi v78, v238 offset:19104
  ds_read_u16_d16_hi v79, v238 offset:27424
  ds_read_u16_d16_hi v48, v237 offset:0
  ds_read_u16_d16_hi v49, v237 offset:8320
  ds_read_u16_d16_hi v50, v238 offset:16640
  ds_read_u16_d16_hi v51, v238 offset:24960
  ds_read_u16_d16_hi v52, v237 offset:128
  ds_read_u16_d16_hi v53, v237 offset:8448
  ds_read_u16_d16_hi v54, v238 offset:16768
  ds_read_u16_d16_hi v55, v238 offset:25088
  ds_read_u16_d16_hi v56, v237 offset:256
  ds_read_u16_d16_hi v57, v237 offset:8576
  ds_read_u16_d16_hi v58, v238 offset:16896
  ds_read_u16_d16_hi v59, v238 offset:25216
  ds_read_u16_d16_hi v60, v237 offset:384
  ds_read_u16_d16_hi v61, v237 offset:8704
  ds_read_u16_d16_hi v62, v238 offset:17024
  ds_read_u16_d16_hi v63, v238 offset:25344
  v_xor_b32 v242, 128, v239
  v_xor_b32 v243, 128, v240
  s_waitcnt lgkmcnt(15)
  v_add_f32 v4, v64, v66
  v_sub_f32 v5, v65, v67
  v_sub_f32 v6, v64, v66
  v_add_f32 v7, v65, v67
  v_mul_f32 v4, 0x35000493, v4
  v_mul_f32 v5, 0x35000493, v5
  v_mul_f32 v204, v6, v123
  v_mul_f32 v205, v7, v123
  v_fma_f32 v200, -v6, v122, v4
  v_fma_f32 v201, -v7, v122, v5
  v_fma_f32 v202, v6, v122, v4
  v_fma_f32 v203, v7, v122, v5
  v_add_f32 v8, v68, v70
  v_sub_f32 v9, v69, v71
  v_sub_f32 v10, v68, v70
  v_add_f32 v11, v69, v71
  v_mul_f32 v8, 0x35000493, v8
  v_mul_f32 v9, 0x35000493, v9
  v_mul_f32 v210, v10, v123
  v_mul_f32 v211, v11, v123
  v_fma_f32 v206, -v10, v122, v8
  v_fma_f32 v207, -v11, v122, v9
  v_fma_f32 v208, v10, v122, v8
  v_fma_f32 v209, v11, v122, v9
  v_add_f32 v4, v72, v74
  v_sub_f32 v5, v73, v75
  v_sub_f32 v6, v72, v74
  v_add_f32 v7, v73, v75
  v_mul_f32 v4, 0x35000493, v4
  v_mul_f32 v5, 0x35000493, v5
  v_mul_f32 v216, v6, v123
  v_mul_f32 v217, v7, v123
  v_fma_f32 v212, -v6, v122, v4
  v_fma_f32 v213, -v7, v122, v5
  v_fma_f32 v214, v6, v122, v4
  v_fma_f32 v215, v7, v122, v5
  v_add_f32 v8, v76, v78
  v_sub_f32 v9, v77, v79
  v_sub_f32 v10, v76, v78
  v_add_f32 v11, v77, v79
  v_mul_f32 v8, 0x35000493, v8
  v_mul_f32 v9, 0x35000493, v9
  v_mul_f32 v222, v10, v123
  v_mul_f32 v223, v11, v123
  v_fma_f32 v218, -v10, v122, v8
  v_fma_f32 v219, -v11, v122, v9
  v_fma_f32 v220, v10, v122, v8
  v_fma_f32 v221, v11, v122, v9
  s_mov_b64 exec, 0xffff
Lpoll_17:
  s_waitcnt vmcnt(0)
  v_cmp_ne_u32 vcc, s40, v245
  s_nop 0
  s_and_b64 exec, exec, vcc
  s_cbranch_scc0 Lpolldone_18
  buffer_load_dword v245, v228, s[24:27], s39 offen sc1
  s_sub_u32 s52, s52, 1
  s_cmp_lg_u32 s52, 0
  s_cbranch_scc1 Lpoll_17
  s_waitcnt vmcnt(0)
Lpolldone_18:
  s_mov_b64 exec, -1
  buffer_load_dwordx4 v230, s[24:27], s38 offen sc1 lds
  s_add_u32 s38, s38, 1024
  s_add_u32 m0, m0, 1024
  s_nop 0
  buffer_load_dwordx4 v231, s[24:27], s38 offen sc1 lds
  s_add_u32 s38, s38, 1024
  s_add_u32 m0, m0, 1024
  s_nop 0
  buffer_load_dwordx4 v230, s[24:27], s38 offen sc1 lds
  s_add_u32 s38, s38, 1024
  s_add_u32 m0, m0, 1024
  s_nop 0
  buffer_load_dwordx4 v231, s[24:27], s38 offen sc1 lds
  s_or_b32 s28, s3, s42
  s_cbranch_scc1 Lskip_19
  v_and_b32 v4, 31, v3
  v_lshlrev_b32 v4, 2, v4
  v_add_u32 v4, 136960, v4
  ds_read_b32 v97, v4 offset:0
  ds_read_b32 v99, v4 offset:512
  ds_read_b32 v101, v4 offset:1024
  ds_read_b32 v103, v4 offset:128
  ds_read_b32 v105, v4 offset:640
  ds_read_b32 v107, v4 offset:1152
  ds_read_b32 v109, v4 offset:256
  ds_read_b32 v111, v4 offset:768
  ds_read_b32 v113, v4 offset:1280
  ds_read_b32 v115, v4 offset:384
  ds_read_b32 v117, v4 offset:896
  ds_read_b32 v119, v4 offset:1408
  s_waitcnt lgkmcnt(11)
  v_lshlrev_b32 v96, 16, v97
  v_and_b32 v97, 0xffff0000, v97
  s_waitcnt lgkmcnt(10)
  v_lshlrev_b32 v98, 16, v99
  v_and_b32 v99, 0xffff0000, v99
  s_waitcnt lgkmcnt(9)
  v_lshlrev_b32 v100, 16, v101
  v_and_b32 v101, 0xffff0000, v101
  s_waitcnt lgkmcnt(8)
  v_lshlrev_b32 v102, 16, v103
  v_and_b32 v103, 0xffff0000, v103
  s_waitcnt lgkmcnt(7)
  v_lshlrev_b32 v104, 16, v105
  v_and_b32 v105, 0xffff0000, v105
  s_waitcnt lgkmcnt(6)
  v_lshlrev_b32 v106, 16, v107
  v_and_b32 v107, 0xffff0000, v107
  s_waitcnt lgkmcnt(5)
  v_lshlrev_b32 v108, 16, v109
  v_and_b32 v109, 0xffff0000, v109
  s_waitcnt lgkmcnt(4)
  v_lshlrev_b32 v110, 16, v111
  v_and_b32 v111, 0xffff0000, v111
  s_waitcnt lgkmcnt(3)
  v_lshlrev_b32 v112, 16, v113
  v_and_b32 v113, 0xffff0000, v113
  s_waitcnt lgkmcnt(2)
  v_lshlrev_b32 v114, 16, v115
  v_and_b32 v115, 0xffff0000, v115
  s_waitcnt lgkmcnt(1)
  v_lshlrev_b32 v116, 16, v117
  v_and_b32 v117, 0xffff0000, v117
  s_waitcnt lgkmcnt(0)
  v_lshlrev_b32 v118, 16, v119
  v_and_b32 v119, 0xffff0000, v119
  s_mov_b32 exec_hi, 0
  v_add_f32 v48, v48, v96
  v_sub_f32 v49, v49, v97
  v_add_f32 v50, v50, v98
  v_sub_f32 v51, v51, v99
  v_mul_f32 v48, 0.5, v48
  v_mul_f32 v49, 0.5, v49
  v_mul_f32 v50, 0.5, v50
  v_mul_f32 v51, 0.5, v51
  v_add_f32 v52, v52, v102
  v_sub_f32 v53, v53, v103
  v_add_f32 v54, v54, v104
  v_sub_f32 v55, v55, v105
  v_mul_f32 v52, 0.5, v52
  v_mul_f32 v53, 0.5, v53
  v_mul_f32 v54, 0.5, v54
  v_mul_f32 v55, 0.5, v55
  v_add_f32 v56, v56, v108
  v_sub_f32 v57, v57, v109
  v_add_f32 v58, v58, v110
  v_sub_f32 v59, v59, v111
  v_mul_f32 v56, 0.5, v56
  v_mul_f32 v57, 0.5, v57
  v_mul_f32 v58, 0.5, v58
  v_mul_f32 v59, 0.5, v59
  v_add_f32 v60, v60, v114
  v_sub_f32 v61, v61, v115
  v_add_f32 v62, v62, v116
  v_sub_f32 v63, v63, v117
  v_mul_f32 v60, 0.5, v60
  v_mul_f32 v61, 0.5, v61
  v_mul_f32 v62, 0.5, v62
  v_mul_f32 v63, 0.5, v63
  s_mov_b64 exec, -1
Lskip_19:
  s_waitcnt lgkmcnt(13)
  v_add_f32 v4, v48, v50
  s_waitcnt lgkmcnt(12)
  v_sub_f32 v5, v49, v51
  v_sub_f32 v6, v48, v50
  v_add_f32 v7, v49, v51
  v_mul_f32 v4, 0x35000493, v4
  v_mul_f32 v5, 0x35000493, v5
  v_mul_f32 v180, v6, v121
  v_mul_f32 v181, v7, v121
  v_fma_f32 v176, -v6, v120, v4
  v_fma_f32 v177, -v7, v120, v5
  v_fma_f32 v178, v6, v120, v4
  v_fma_f32 v179, v7, v120, v5
  s_waitcnt lgkmcnt(9)
  v_add_f32 v8, v52, v54
  s_waitcnt lgkmcnt(8)
  v_sub_f32 v9, v53, v55
  v_sub_f32 v10, v52, v54
  v_add_f32 v11, v53, v55
  v_mul_f32 v8, 0x35000493, v8
  v_mul_f32 v9, 0x35000493, v9
  v_mul_f32 v186, v10, v121
  v_mul_f32 v187, v11, v121
  v_fma_f32 v182, -v10, v120, v8
  v_fma_f32 v183, -v11, v120, v9
  v_fma_f32 v184, v10, v120, v8
  v_fma_f32 v185, v11, v120, v9
  s_waitcnt lgkmcnt(5)
  v_add_f32 v4, v56, v58
  s_waitcnt lgkmcnt(4)
  v_sub_f32 v5, v57, v59
  v_sub_f32 v6, v56, v58
  v_add_f32 v7, v57, v59
  v_mul_f32 v4, 0x35000493, v4
  v_mul_f32 v5, 0x35000493, v5
  v_mul_f32 v192, v6, v121
  v_mul_f32 v193, v7, v121
  v_fma_f32 v188, -v6, v120, v4
  v_fma_f32 v189, -v7, v120, v5
  v_fma_f32 v190, v6, v120, v4
  v_fma_f32 v191, v7, v120, v5
  s_waitcnt lgkmcnt(1)
  v_add_f32 v8, v60, v62
  s_waitcnt lgkmcnt(0)
  v_sub_f32 v9, v61, v63
  v_sub_f32 v10, v60, v62
  v_add_f32 v11, v61, v63
  v_mul_f32 v8, 0x35000493, v8
  v_mul_f32 v9, 0x35000493, v9
  v_mul_f32 v198, v10, v121
  v_mul_f32 v199, v11, v121
  v_fma_f32 v194, -v10, v120, v8
  v_fma_f32 v195, -v11, v120, v9
  v_fma_f32 v196, v10, v120, v8
  v_fma_f32 v197, v11, v120, v9
  s_or_b32 s28, s3, s42
  s_cselect_b32 s46, 0, s46
  s_cmp_eq_u32 s46, 0
  s_cbranch_scc1 Lskip_20
  s_mov_b32 exec_hi, 0
  v_mul_f32 v178, 0x35800493, v100
  v_mul_f32 v179, 0x35800493, v101
  v_mul_f32 v184, 0x35800493, v106
  v_mul_f32 v185, 0x35800493, v107
  v_mul_f32 v190, 0x35800493, v112
  v_mul_f32 v191, 0x35800493, v113
  v_mul_f32 v196, 0x35800493, v118
  v_mul_f32 v197, 0x35800493, v119
  s_mov_b64 exec, -1
  v_and_b32 v4, 1, v2
  v_lshl_add_u32 v4, v4, 6, v1
  v_lshlrev_b32 v124, 3, v4
  v_add_u32 v124, 135936, v124
  s_cmp_eq_u32 s41, 0
  s_cselect_b32 s28, 0, -1
  v_add_u32 v5, 0, v4
  v_sub_u32 v5, s28, v5
  v_and_b32 v5, 127, v5
  v_lshlrev_b32 v5, 3, v5
  v_add_u32 v125, 135936, v5
  v_add_u32 v5, 16, v4
  v_sub_u32 v5, s28, v5
  v_and_b32 v5, 127, v5
  v_lshlrev_b32 v5, 3, v5
  v_add_u32 v126, 135936, v5
  v_add_u32 v5, 32, v4
  v_sub_u32 v5, s28, v5
  v_and_b32 v5, 127, v5
  v_lshlrev_b32 v5, 3, v5
  v_add_u32 v127, 135936, v5
  v_add_u32 v5, 48, v4
  v_sub_u32 v5, s28, v5
  v_and_b32 v5, 127, v5
  v_lshlrev_b32 v5, 3, v5
  v_add_u32 v128, 135936, v5
Lskip_20:
  s_waitcnt vmcnt(0)
  s_barrier
  ds_read2st64_b32 v[32:33], v232 offset0:0 offset1:8
  ds_read2st64_b32 v[34:35], v232 offset0:16 offset1:24
  ds_read2st64_b32 v[36:37], v233 offset0:0 offset1:8
  ds_read2st64_b32 v[38:39], v233 offset0:16 offset1:24
  ds_read2st64_b32 v[40:41], v234 offset0:0 offset1:8
  ds_read2st64_b32 v[42:43], v234 offset0:16 offset1:24
  ds_read2st64_b32 v[44:45], v235 offset0:0 offset1:8
  ds_read2st64_b32 v[46:47], v235 offset0:16 offset1:24
  s_waitcnt lgkmcnt(6)
  v_mfma_f32_16x16x32_bf16 v[48:51], v[32:35], v[136:139], 0
  v_mfma_f32_16x16x32_bf16 v[52:55], v[32:35], v[140:143], 0
  s_waitcnt lgkmcnt(4)
  v_mfma_f32_16x16x32_bf16 v[56:59], v[36:39], v[136:139], 0
  v_mfma_f32_16x16x32_bf16 v[60:63], v[36:39], v[140:143], 0
  s_waitcnt lgkmcnt(2)
  v_mfma_f32_16x16x32_bf16 v[64:67], v[40:43], v[136:139], 0
  v_mfma_f32_16x16x32_bf16 v[68:71], v[40:43], v[140:143], 0
  s_waitcnt lgkmcnt(0)
  v_mfma_f32_16x16x32_bf16 v[72:75], v[44:47], v[136:139], 0
  v_mfma_f32_16x16x32_bf16 v[76:79], v[44:47], v[140:143], 0
  s_or_b32 s28, s3, s2
  s_cbranch_scc1 Lskip_21
  s_mov_b32 s28, 11010048
  s_mov_b64 exec, 1
  buffer_store_dword v229, off, s[24:27], s28 sc1
  s_mov_b64 exec, -1
Lskip_21:
  v_mul_f32 v4, v48, v144
  v_mul_f32 v5, v52, v144
  v_mul_f32 v6, v49, v146
  v_mul_f32 v7, v53, v146
  v_mul_f32 v8, v50, v148
  v_mul_f32 v9, v54, v148
  v_mul_f32 v10, v51, v150
  v_mul_f32 v11, v55, v150
  v_fmac_f32 v4, v52, v145
  v_fma_f32 v5, -v48, v145, v5
  v_fmac_f32 v6, v53, v147
  v_fma_f32 v7, -v49, v147, v7
  v_fmac_f32 v8, v54, v149
  v_fma_f32 v9, -v50, v149, v9
  v_fmac_f32 v10, v55, v151
  v_fma_f32 v11, -v51, v151, v11
  v_perm_b32 v32, v5, v4, s47
  v_perm_b32 v33, v7, v6, s47
  v_perm_b32 v34, v9, v8, s47
  v_perm_b32 v35, v11, v10, s47
  v_mul_f32 v4, v56, v144
  v_mul_f32 v5, v60, v144
  v_mul_f32 v6, v57, v146
  v_mul_f32 v7, v61, v146
  v_mul_f32 v8, v58, v148
  v_mul_f32 v9, v62, v148
  v_mul_f32 v10, v59, v150
  v_mul_f32 v11, v63, v150
  v_fmac_f32 v4, v60, v145
  v_fma_f32 v5, -v56, v145, v5
  v_fmac_f32 v6, v61, v147
  v_fma_f32 v7, -v57, v147, v7
  v_fmac_f32 v8, v62, v149
  v_fma_f32 v9, -v58, v149, v9
  v_fmac_f32 v10, v63, v151
  v_fma_f32 v11, -v59, v151, v11
  v_perm_b32 v36, v5, v4, s47
  v_perm_b32 v37, v7, v6, s47
  v_perm_b32 v38, v9, v8, s47
  v_perm_b32 v39, v11, v10, s47
  v_mul_f32 v4, v64, v144
  v_mul_f32 v5, v68, v144
  v_mul_f32 v6, v65, v146
  v_mul_f32 v7, v69, v146
  v_mul_f32 v8, v66, v148
  v_mul_f32 v9, v70, v148
  v_mul_f32 v10, v67, v150
  v_mul_f32 v11, v71, v150
  v_fmac_f32 v4, v68, v145
  v_fma_f32 v5, -v64, v145, v5
  v_fmac_f32 v6, v69, v147
  v_fma_f32 v7, -v65, v147, v7
  v_fmac_f32 v8, v70, v149
  v_fma_f32 v9, -v66, v149, v9
  v_fmac_f32 v10, v71, v151
  v_fma_f32 v11, -v67, v151, v11
  v_perm_b32 v40, v5, v4, s47
  v_perm_b32 v41, v7, v6, s47
  v_perm_b32 v42, v9, v8, s47
  v_perm_b32 v43, v11, v10, s47
  v_mul_f32 v4, v72, v144
  v_mul_f32 v5, v76, v144
  v_mul_f32 v6, v73, v146
  v_mul_f32 v7, v77, v146
  v_mul_f32 v8, v74, v148
  v_mul_f32 v9, v78, v148
  v_mul_f32 v10, v75, v150
  v_mul_f32 v11, v79, v150
  v_fmac_f32 v4, v76, v145
  v_fma_f32 v5, -v72, v145, v5
  v_fmac_f32 v6, v77, v147
  v_fma_f32 v7, -v73, v147, v7
  v_fmac_f32 v8, v78, v149
  v_fma_f32 v9, -v74, v149, v9
  v_fmac_f32 v10, v79, v151
  v_fma_f32 v11, -v75, v151, v11
  v_perm_b32 v44, v5, v4, s47
  v_perm_b32 v45, v7, v6, s47
  v_perm_b32 v46, v9, v8, s47
  v_perm_b32 v47, v11, v10, s47
  v_mfma_f32_16x16x32_bf16 v[48:51], v[152:155], v[32:35], 0
  v_mfma_f32_16x16x32_bf16 v[52:55], v[156:159], v[32:35], 0
  v_mfma_f32_16x16x32_bf16 v[56:59], v[152:155], v[36:39], 0
  v_mfma_f32_16x16x32_bf16 v[60:63], v[156:159], v[36:39], 0
  v_mfma_f32_16x16x32_bf16 v[64:67], v[152:155], v[40:43], 0
  v_mfma_f32_16x16x32_bf16 v[68:71], v[156:159], v[40:43], 0
  v_mfma_f32_16x16x32_bf16 v[72:75], v[152:155], v[44:47], 0
  v_mfma_f32_16x16x32_bf16 v[76:79], v[156:159], v[44:47], 0
  s_cmp_lg_u32 s46, 0
  s_cbranch_scc1 Lelse_22
  v_mul_f32 v4, v176, v48
  v_mul_f32 v5, v176, v52
  v_mul_f32 v6, v178, v56
  v_mul_f32 v7, v178, v60
  v_mul_f32 v8, v182, v49
  v_mul_f32 v9, v182, v53
  v_mul_f32 v10, v184, v57
  v_mul_f32 v11, v184, v61
  v_fma_f32 v4, -v177, v52, v4
  v_fmac_f32 v5, v177, v48
  v_fma_f32 v6, -v179, v60, v6
  v_fmac_f32 v7, v179, v56
  v_fma_f32 v8, -v183, v53, v8
  v_fmac_f32 v9, v183, v49
  v_fma_f32 v10, -v185, v61, v10
  v_fmac_f32 v11, v185, v57
  v_fma_f32 v4, -v180, v60, v4
  v_fmac_f32 v5, v180, v56
  v_fmac_f32 v6, v180, v52
  v_fma_f32 v7, -v180, v48, v7
  v_fma_f32 v8, -v186, v61, v8
  v_fmac_f32 v9, v186, v57
  v_fmac_f32 v10, v186, v53
  v_fma_f32 v11, -v186, v49, v11
  v_fma_f32 v4, -v181, v56, v4
  v_fma_f32 v5, -v181, v60, v5
  v_fmac_f32 v6, v181, v48
  v_fmac_f32 v7, v181, v52
  v_fma_f32 v8, -v187, v57, v8
  v_fma_f32 v9, -v187, v61, v9
  v_fmac_f32 v10, v187, v49
  v_fmac_f32 v11, v187, v53
  v_perm_b32 v32, v4, v5, s47
  v_perm_b32 v36, v6, v7, s47
  v_perm_b32 v33, v8, v9, s47
  v_perm_b32 v37, v10, v11, s47
  v_mul_f32 v4, v188, v50
  v_mul_f32 v5, v188, v54
  v_mul_f32 v6, v190, v58
  v_mul_f32 v7, v190, v62
  v_mul_f32 v8, v194, v51
  v_mul_f32 v9, v194, v55
  v_mul_f32 v10, v196, v59
  v_mul_f32 v11, v196, v63
  v_fma_f32 v4, -v189, v54, v4
  v_fmac_f32 v5, v189, v50
  v_fma_f32 v6, -v191, v62, v6
  v_fmac_f32 v7, v191, v58
  v_fma_f32 v8, -v195, v55, v8
  v_fmac_f32 v9, v195, v51
  v_fma_f32 v10, -v197, v63, v10
  v_fmac_f32 v11, v197, v59
  v_fma_f32 v4, -v192, v62, v4
  v_fmac_f32 v5, v192, v58
  v_fmac_f32 v6, v192, v54
  v_fma_f32 v7, -v192, v50, v7
  v_fma_f32 v8, -v198, v63, v8
  v_fmac_f32 v9, v198, v59
  v_fmac_f32 v10, v198, v55
  v_fma_f32 v11, -v198, v51, v11
  v_fma_f32 v4, -v193, v58, v4
  v_fma_f32 v5, -v193, v62, v5
  v_fmac_f32 v6, v193, v50
  v_fmac_f32 v7, v193, v54
  v_fma_f32 v8, -v199, v59, v8
  v_fma_f32 v9, -v199, v63, v9
  v_fmac_f32 v10, v199, v51
  v_fmac_f32 v11, v199, v55
  v_perm_b32 v34, v4, v5, s47
  v_perm_b32 v38, v6, v7, s47
  v_perm_b32 v35, v8, v9, s47
  v_perm_b32 v39, v10, v11, s47
  s_branch Lend_23
Lelse_22:
  s_mov_b32 exec_hi, 0
  ds_write2_b32 v124, v48, v52 offset0:0 offset1:1
  ds_write2_b32 v124, v49, v53 offset0:32 offset1:33
  ds_write2_b32 v124, v50, v54 offset0:64 offset1:65
  ds_write2_b32 v124, v51, v55 offset0:96 offset1:97
  ds_read_b64 v[4:5], v125
  ds_read_b64 v[6:7], v126
  ds_read_b64 v[8:9], v127
  ds_read_b64 v[10:11], v128
  s_mov_b64 exec, -1
  v_mov_b32 v16, v56
  v_mov_b32 v24, v48
  v_mov_b32 v17, v57
  v_mov_b32 v25, v49
  v_mov_b32 v18, v58
  v_mov_b32 v26, v50
  v_mov_b32 v19, v59
  v_mov_b32 v27, v51
  v_mov_b32 v20, v60
  v_mov_b32 v28, v52
  v_mov_b32 v21, v61
  v_mov_b32 v29, v53
  v_mov_b32 v22, v62
  v_mov_b32 v30, v54
  v_mov_b32 v23, v63
  v_mov_b32 v31, v55
  s_mov_b32 exec_hi, 0
  s_waitcnt lgkmcnt(3)
  v_mov_b32 v16, v4
  v_xor_b32 v20, 0x80000000, v5
  s_waitcnt lgkmcnt(2)
  v_mov_b32 v17, v6
  v_xor_b32 v21, 0x80000000, v7
  s_waitcnt lgkmcnt(1)
  v_mov_b32 v18, v8
  v_xor_b32 v22, 0x80000000, v9
  s_waitcnt lgkmcnt(0)
  v_mov_b32 v19, v10
  v_xor_b32 v23, 0x80000000, v11
  v_mov_b32 v24, 0
  v_mov_b32 v25, 0
  v_mov_b32 v26, 0
  v_mov_b32 v27, 0
  v_mov_b32 v28, 0
  v_mov_b32 v29, 0
  v_mov_b32 v30, 0
  v_mov_b32 v31, 0
  s_mov_b64 exec, -1
  v_mul_f32 v4, v176, v48
  v_mul_f32 v5, v176, v52
  v_mul_f32 v6, v178, v56
  v_mul_f32 v7, v178, v60
  v_mul_f32 v8, v182, v49
  v_mul_f32 v9, v182, v53
  v_mul_f32 v10, v184, v57
  v_mul_f32 v11, v184, v61
  v_fma_f32 v4, -v177, v52, v4
  v_fmac_f32 v5, v177, v48
  v_fma_f32 v6, -v179, v60, v6
  v_fmac_f32 v7, v179, v56
  v_fma_f32 v8, -v183, v53, v8
  v_fmac_f32 v9, v183, v49
  v_fma_f32 v10, -v185, v61, v10
  v_fmac_f32 v11, v185, v57
  v_fma_f32 v4, -v180, v20, v4
  v_fmac_f32 v5, v180, v16
  v_fmac_f32 v6, v180, v28
  v_fma_f32 v7, -v180, v24, v7
  v_fma_f32 v8, -v186, v21, v8
  v_fmac_f32 v9, v186, v17
  v_fmac_f32 v10, v186, v29
  v_fma_f32 v11, -v186, v25, v11
  v_fma_f32 v4, -v181, v16, v4
  v_fma_f32 v5, -v181, v20, v5
  v_fmac_f32 v6, v181, v24
  v_fmac_f32 v7, v181, v28
  v_fma_f32 v8, -v187, v17, v8
  v_fma_f32 v9, -v187, v21, v9
  v_fmac_f32 v10, v187, v25
  v_fmac_f32 v11, v187, v29
  v_perm_b32 v32, v4, v5, s47
  v_perm_b32 v36, v6, v7, s47
  v_perm_b32 v33, v8, v9, s47
  v_perm_b32 v37, v10, v11, s47
  v_mul_f32 v4, v188, v50
  v_mul_f32 v5, v188, v54
  v_mul_f32 v6, v190, v58
  v_mul_f32 v7, v190, v62
  v_mul_f32 v8, v194, v51
  v_mul_f32 v9, v194, v55
  v_mul_f32 v10, v196, v59
  v_mul_f32 v11, v196, v63
  v_fma_f32 v4, -v189, v54, v4
  v_fmac_f32 v5, v189, v50
  v_fma_f32 v6, -v191, v62, v6
  v_fmac_f32 v7, v191, v58
  v_fma_f32 v8, -v195, v55, v8
  v_fmac_f32 v9, v195, v51
  v_fma_f32 v10, -v197, v63, v10
  v_fmac_f32 v11, v197, v59
  v_fma_f32 v4, -v192, v22, v4
  v_fmac_f32 v5, v192, v18
  v_fmac_f32 v6, v192, v30
  v_fma_f32 v7, -v192, v26, v7
  v_fma_f32 v8, -v198, v23, v8
  v_fmac_f32 v9, v198, v19
  v_fmac_f32 v10, v198, v31
  v_fma_f32 v11, -v198, v27, v11
  v_fma_f32 v4, -v193, v18, v4
  v_fma_f32 v5, -v193, v22, v5
  v_fmac_f32 v6, v193, v26
  v_fmac_f32 v7, v193, v30
  v_fma_f32 v8, -v199, v19, v8
  v_fma_f32 v9, -v199, v23, v9
  v_fmac_f32 v10, v199, v27
  v_fmac_f32 v11, v199, v31
  v_perm_b32 v34, v4, v5, s47
  v_perm_b32 v38, v6, v7, s47
  v_perm_b32 v35, v8, v9, s47
  v_perm_b32 v39, v10, v11, s47
Lend_23:
  v_mul_f32 v4, v200, v64
  v_mul_f32 v5, v200, v68
  v_mul_f32 v6, v202, v72
  v_mul_f32 v7, v202, v76
  v_mul_f32 v8, v206, v65
  v_mul_f32 v9, v206, v69
  v_mul_f32 v10, v208, v73
  v_mul_f32 v11, v208, v77
  v_fma_f32 v4, -v201, v68, v4
  v_fmac_f32 v5, v201, v64
  v_fma_f32 v6, -v203, v76, v6
  v_fmac_f32 v7, v203, v72
  v_fma_f32 v8, -v207, v69, v8
  v_fmac_f32 v9, v207, v65
  v_fma_f32 v10, -v209, v77, v10
  v_fmac_f32 v11, v209, v73
  v_fma_f32 v4, -v204, v76, v4
  v_fmac_f32 v5, v204, v72
  v_fmac_f32 v6, v204, v68
  v_fma_f32 v7, -v204, v64, v7
  v_fma_f32 v8, -v210, v77, v8
  v_fmac_f32 v9, v210, v73
  v_fmac_f32 v10, v210, v69
  v_fma_f32 v11, -v210, v65, v11
  v_fma_f32 v4, -v205, v72, v4
  v_fma_f32 v5, -v205, v76, v5
  v_fmac_f32 v6, v205, v64
  v_fmac_f32 v7, v205, v68
  v_fma_f32 v8, -v211, v73, v8
  v_fma_f32 v9, -v211, v77, v9
  v_fmac_f32 v10, v211, v65
  v_fmac_f32 v11, v211, v69
  v_perm_b32 v40, v4, v5, s47
  v_perm_b32 v44, v6, v7, s47
  v_perm_b32 v41, v8, v9, s47
  v_perm_b32 v45, v10, v11, s47
  v_mul_f32 v4, v212, v66
  v_mul_f32 v5, v212, v70
  v_mul_f32 v6, v214, v74
  v_mul_f32 v7, v214, v78
  v_mul_f32 v8, v218, v67
  v_mul_f32 v9, v218, v71
  v_mul_f32 v10, v220, v75
  v_mul_f32 v11, v220, v79
  v_fma_f32 v4, -v213, v70, v4
  v_fmac_f32 v5, v213, v66
  v_fma_f32 v6, -v215, v78, v6
  v_fmac_f32 v7, v215, v74
  v_fma_f32 v8, -v219, v71, v8
  v_fmac_f32 v9, v219, v67
  v_fma_f32 v10, -v221, v79, v10
  v_fmac_f32 v11, v221, v75
  v_fma_f32 v4, -v216, v78, v4
  v_fmac_f32 v5, v216, v74
  v_fmac_f32 v6, v216, v70
  v_fma_f32 v7, -v216, v66, v7
  v_fma_f32 v8, -v222, v79, v8
  v_fmac_f32 v9, v222, v75
  v_fmac_f32 v10, v222, v71
  v_fma_f32 v11, -v222, v67, v11
  v_fma_f32 v4, -v217, v74, v4
  v_fma_f32 v5, -v217, v78, v5
  v_fmac_f32 v6, v217, v66
  v_fmac_f32 v7, v217, v70
  v_fma_f32 v8, -v223, v75, v8
  v_fma_f32 v9, -v223, v79, v9
  v_fmac_f32 v10, v223, v67
  v_fmac_f32 v11, v223, v71
  v_perm_b32 v42, v4, v5, s47
  v_perm_b32 v46, v6, v7, s47
  v_perm_b32 v43, v8, v9, s47
  v_perm_b32 v47, v10, v11, s47
  v_mfma_f32_16x16x32_bf16 v[48:51], v[32:35], v[152:155], 0
  v_mfma_f32_16x16x32_bf16 v[52:55], v[32:35], v[156:159], 0
  v_mfma_f32_16x16x32_bf16 v[56:59], v[36:39], v[152:155], 0
  v_mfma_f32_16x16x32_bf16 v[60:63], v[36:39], v[156:159], 0
  v_mfma_f32_16x16x32_bf16 v[64:67], v[40:43], v[152:155], 0
  v_mfma_f32_16x16x32_bf16 v[68:71], v[40:43], v[156:159], 0
  v_mfma_f32_16x16x32_bf16 v[72:75], v[44:47], v[152:155], 0
  v_mfma_f32_16x16x32_bf16 v[76:79], v[44:47], v[156:159], 0
  s_mul_i32 s28, s3, 526336
  s_add_u32 s28, s28, 5242880
  s_add_u32 s29, s28, 263168
  s_add_u32 s30, s28, s44
  s_add_u32 s31, s29, s44
  v_mul_f32 v4, v48, v160
  v_mul_f32 v5, v52, v160
  v_mul_f32 v6, v49, v162
  v_mul_f32 v7, v53, v162
  v_mul_f32 v8, v50, v164
  v_mul_f32 v9, v54, v164
  v_mul_f32 v10, v51, v166
  v_mul_f32 v11, v55, v166
  v_fmac_f32 v4, v52, v161
  v_fma_f32 v5, -v48, v161, v5
  v_fmac_f32 v6, v53, v163
  v_fma_f32 v7, -v49, v163, v7
  v_fmac_f32 v8, v54, v165
  v_fma_f32 v9, -v50, v165, v9
  v_fmac_f32 v10, v55, v167
  v_fma_f32 v11, -v51, v167, v11
  v_perm_b32 v32, v5, v4, s47
  v_perm_b32 v33, v7, v6, s47
  v_perm_b32 v34, v9, v8, s47
  v_perm_b32 v35, v11, v10, s47
  v_mul_f32 v4, v64, v160
  v_mul_f32 v5, v68, v160
  v_mul_f32 v6, v65, v162
  v_mul_f32 v7, v69, v162
  v_mul_f32 v8, v66, v164
  v_mul_f32 v9, v70, v164
  v_mul_f32 v10, v67, v166
  v_mul_f32 v11, v71, v166
  v_fmac_f32 v4, v68, v161
  v_fma_f32 v5, -v64, v161, v5
  v_fmac_f32 v6, v69, v163
  v_fma_f32 v7, -v65, v163, v7
  v_fmac_f32 v8, v70, v165
  v_fma_f32 v9, -v66, v165, v9
  v_fmac_f32 v10, v71, v167
  v_fma_f32 v11, -v67, v167, v11
  v_perm_b32 v40, v5, v4, s47
  v_perm_b32 v41, v7, v6, s47
  v_perm_b32 v42, v9, v8, s47
  v_perm_b32 v43, v11, v10, s47
  v_mfma_f32_16x16x32_bf16 v[48:51], v[168:171], v[32:35], 0
  v_mfma_f32_16x16x32_bf16 v[52:55], v[172:175], v[32:35], 0
  v_mfma_f32_16x16x32_bf16 v[64:67], v[168:171], v[40:43], 0
  v_mfma_f32_16x16x32_bf16 v[68:71], v[172:175], v[40:43], 0
  v_mul_f32 v4, v56, v160
  v_mul_f32 v5, v60, v160
  v_mul_f32 v6, v57, v162
  v_mul_f32 v7, v61, v162
  v_mul_f32 v8, v58, v164
  v_mul_f32 v9, v62, v164
  v_mul_f32 v10, v59, v166
  v_mul_f32 v11, v63, v166
  v_fmac_f32 v4, v60, v161
  v_fma_f32 v5, -v56, v161, v5
  v_fmac_f32 v6, v61, v163
  v_fma_f32 v7, -v57, v163, v7
  v_fmac_f32 v8, v62, v165
  v_fma_f32 v9, -v58, v165, v9
  v_fmac_f32 v10, v63, v167
  v_fma_f32 v11, -v59, v167, v11
  v_perm_b32 v36, v5, v4, s47
  v_perm_b32 v37, v7, v6, s47
  v_perm_b32 v38, v9, v8, s47
  v_perm_b32 v39, v11, v10, s47
  v_perm_b32 v16, v52, v48, s47
  v_perm_b32 v17, v68, v64, s47
  ds_write_b64 v239, v[16:17] offset:0
  v_perm_b32 v18, v53, v49, s47
  v_perm_b32 v19, v69, v65, s47
  ds_write_b64 v239, v[18:19] offset:2048
  v_perm_b32 v20, v54, v50, s47
  v_perm_b32 v21, v70, v66, s47
  ds_write_b64 v239, v[20:21] offset:4096
  v_perm_b32 v22, v55, v51, s47
  v_perm_b32 v23, v71, v67, s47
  ds_write_b64 v239, v[22:23] offset:6144
  s_waitcnt lgkmcnt(0)
  s_barrier
  ds_read_b128 v[176:179], v240 offset:0
  ds_read_b128 v[180:183], v240 offset:2048
  v_mul_f32 v4, v72, v160
  v_mul_f32 v5, v76, v160
  v_mul_f32 v6, v73, v162
  v_mul_f32 v7, v77, v162
  v_mul_f32 v8, v74, v164
  v_mul_f32 v9, v78, v164
  v_mul_f32 v10, v75, v166
  v_mul_f32 v11, v79, v166
  v_fmac_f32 v4, v76, v161
  v_fma_f32 v5, -v72, v161, v5
  v_fmac_f32 v6, v77, v163
  v_fma_f32 v7, -v73, v163, v7
  v_fmac_f32 v8, v78, v165
  v_fma_f32 v9, -v74, v165, v9
  v_fmac_f32 v10, v79, v167
  v_fma_f32 v11, -v75, v167, v11
  v_perm_b32 v44, v5, v4, s47
  v_perm_b32 v45, v7, v6, s47
  v_perm_b32 v46, v9, v8, s47
  v_perm_b32 v47, v11, v10, s47
  v_mfma_f32_16x16x32_bf16 v[56:59], v[168:171], v[36:39], 0
  v_mfma_f32_16x16x32_bf16 v[60:63], v[172:175], v[36:39], 0
  v_mfma_f32_16x16x32_bf16 v[72:75], v[168:171], v[44:47], 0
  v_mfma_f32_16x16x32_bf16 v[76:79], v[172:175], v[44:47], 0
  s_waitcnt lgkmcnt(1)
  buffer_store_dwordx4 v[176:179], v241, s[24:27], s28 offen sc1
  s_waitcnt lgkmcnt(0)
  buffer_store_dwordx4 v[180:183], v241, s[24:27], s29 offen sc1
  s_nop 1
  v_perm_b32 v24, v60, v56, s47
  s_nop 0
  v_perm_b32 v25, v76, v72, s47
  ds_write_b64 v242, v[24:25] offset:0
  v_perm_b32 v26, v61, v57, s47
  v_perm_b32 v27, v77, v73, s47
  ds_write_b64 v242, v[26:27] offset:2048
  v_perm_b32 v28, v62, v58, s47
  v_perm_b32 v29, v78, v74, s47
  ds_write_b64 v242, v[28:29] offset:4096
  v_perm_b32 v30, v63, v59, s47
  v_perm_b32 v31, v79, v75, s47
  ds_write_b64 v242, v[30:31] offset:6144
  s_waitcnt lgkmcnt(0)
  s_barrier
  ds_read_b128 v[184:187], v243 offset:0
  ds_read_b128 v[188:191], v243 offset:2048
  s_waitcnt lgkmcnt(1)
  buffer_store_dwordx4 v[184:187], v241, s[24:27], s30 offen sc1
  s_waitcnt lgkmcnt(0)
  buffer_store_dwordx4 v[188:191], v241, s[24:27], s31 offen sc1
  s_add_u32 s45, s45, 262144
  s_add_u32 s28, s53, s3
  v_lshl_add_u32 v228, v3, 3, s28
  v_mul_u32_u24 v228, 128, v228
  v_add_f32 v4, v248, v248
  v_add_f32 v5, 1.0, v4
  v_mul_f32 v6, 0x3e000000, v249
  v_mul_f32 v16, v4, v6
  v_mul_f32 v20, v5, v6
  v_fmamk_f32 v19, v4, 0x3dc00000, v16
  v_fmamk_f32 v18, v4, 0x3d800000, v16
  v_fmamk_f32 v17, v4, 0x3d000000, v16
  v_fmamk_f32 v23, v5, 0x3dc00000, v20
  v_fmamk_f32 v22, v5, 0x3d800000, v20
  v_fmamk_f32 v21, v5, 0x3d000000, v20
  v_cos_f32 v48, v16
  v_sin_f32 v49, v16
  v_cos_f32 v50, v17
  v_sin_f32 v51, v17
  v_cos_f32 v52, v18
  v_sin_f32 v53, v18
  v_cos_f32 v54, v19
  v_sin_f32 v55, v19
  v_cvt_pk_bf16_f32 v112, v48, v49
  v_cvt_pk_bf16_f32 v116, -v49, v48
  v_cvt_pk_bf16_f32 v113, v50, v51
  v_cvt_pk_bf16_f32 v117, -v51, v50
  v_cvt_pk_bf16_f32 v114, v52, v53
  v_cvt_pk_bf16_f32 v118, -v53, v52
  v_cvt_pk_bf16_f32 v115, v54, v55
  v_cvt_pk_bf16_f32 v119, -v55, v54
  v_cos_f32 v56, v20
  v_sin_f32 v57, v20
  v_cos_f32 v58, v21
  v_sin_f32 v59, v21
  v_cos_f32 v60, v22
  v_sin_f32 v61, v22
  v_cos_f32 v62, v23
  v_sin_f32 v63, v23
  v_cvt_pk_bf16_f32 v120, v56, v57
  v_cvt_pk_bf16_f32 v124, -v57, v56
  v_cvt_pk_bf16_f32 v121, v58, v59
  v_cvt_pk_bf16_f32 v125, -v59, v58
  v_cvt_pk_bf16_f32 v122, v60, v61
  v_cvt_pk_bf16_f32 v126, -v61, v60
  v_cvt_pk_bf16_f32 v123, v62, v63
  v_cvt_pk_bf16_f32 v127, -v63, v62
  v_xor_b32 v128, 0x80008000, v120
  v_xor_b32 v129, 0x80008000, v121
  v_xor_b32 v130, 0x80008000, v122
  v_xor_b32 v131, 0x80008000, v123
  v_xor_b32 v132, 0x80008000, v124
  v_xor_b32 v133, 0x80008000, v125
  v_xor_b32 v134, 0x80008000, v126
  v_xor_b32 v135, 0x80008000, v127
  s_waitcnt vmcnt(0)
  s_barrier
  s_cmp_lg_u32 s3, 0
  s_cbranch_scc1 Lskip_24
  s_mov_b64 exec, 1
  buffer_store_dword v229, v250, s[24:27], s45 offen sc1
  s_mov_b64 exec, -1
Lskip_24:
  v_mul_f32 v6, 0x3c000000, v249
  v_mul_f32 v16, v4, v6
  v_mul_f32 v20, v5, v6
  v_fmamk_f32 v19, v4, 0x3bc00000, v16
  v_fmamk_f32 v18, v4, 0x3b800000, v16
  v_fmamk_f32 v17, v4, 0x3b000000, v16
  v_fmamk_f32 v23, v5, 0x3bc00000, v20
  v_fmamk_f32 v22, v5, 0x3b800000, v20
  v_fmamk_f32 v21, v5, 0x3b000000, v20
  v_cos_f32 v96, v16
  v_sin_f32 v97, v16
  v_cos_f32 v98, v17
  v_sin_f32 v99, v17
  v_cos_f32 v100, v18
  v_sin_f32 v101, v18
  v_cos_f32 v102, v19
  v_sin_f32 v103, v19
  v_cos_f32 v104, v20
  v_sin_f32 v105, v20
  v_cos_f32 v106, v21
  v_sin_f32 v107, v21
  v_cos_f32 v108, v22
  v_sin_f32 v109, v22
  v_cos_f32 v110, v23
  v_sin_f32 v111, v23
  v_mul_f32 v96, 0x3f80b912, v96
  v_mul_f32 v97, 0x3f80b912, v97
  v_mul_f32 v98, 0x3f80b912, v98
  v_mul_f32 v99, 0x3f80b912, v99
  v_mul_f32 v100, 0x3f80b912, v100
  v_mul_f32 v101, 0x3f80b912, v101
  v_mul_f32 v102, 0x3f80b912, v102
  v_mul_f32 v103, 0x3f80b912, v103
  v_mul_f32 v104, 0x3f80b912, v104
  v_mul_f32 v105, 0x3f80b912, v105
  v_mul_f32 v106, 0x3f80b912, v106
  v_mul_f32 v107, 0x3f80b912, v107
  v_mul_f32 v108, 0x3f80b912, v108
  v_mul_f32 v109, 0x3f80b912, v109
  v_mul_f32 v110, 0x3f80b912, v110
  v_mul_f32 v111, 0x3f80b912, v111
  v_mul_f32 v6, 0x3e000000, v249
  v_mul_f32 v16, v248, v6
  v_fmamk_f32 v18, v248, 0x3d800000, v16
  v_mul_f32 v7, 0.5, v248
  v_cmp_eq_u32 vcc, 0, v2
  s_nop 1
  v_cndmask_b32 v17, v16, v7, vcc
  v_mov_b32 v8, 0x80008000
  v_cndmask_b32 v8, v8, 0, vcc
  v_cos_f32 v48, v16
  v_sin_f32 v49, v16
  v_cos_f32 v50, v17
  v_sin_f32 v51, v17
  v_cos_f32 v52, v18
  v_sin_f32 v53, v18
  v_cvt_pk_bf16_f32 v84, v48, v49
  v_cvt_pk_bf16_f32 v80, -v49, v48
  v_cvt_pk_bf16_f32 v85, v50, v51
  v_cvt_pk_bf16_f32 v81, -v51, v50
  v_cvt_pk_bf16_f32 v86, v52, v53
  v_cvt_pk_bf16_f32 v82, -v53, v52
  v_mov_b32 v83, v82
  v_xor_b32 v87, 0x80008000, v86
  v_xor_b32 v85, v8, v85
  s_lshl_b32 s28, s3, 12
  s_mul_i32 s29, s2, 32896
  s_add_u32 s29, s29, 5242880
  s_add_u32 s28, s28, s29
  v_lshl_add_u32 v224, v3, 4, s28
  v_lshrrev_b32 v4, 1, v1
  v_and_b32 v5, 4, v4
  v_bfe_u32 v6, v4, 1, 1
  v_and_b32 v4, 1, v4
  v_lshl_or_b32 v4, v4, 1, v5
  v_or_b32 v4, v4, v6
  v_xor_b32 v4, s3, v4
  v_lshlrev_b32 v4, 3, v4
  v_lshl_or_b32 v4, v1, 6, v4
  v_mul_u32_u24 v5, 8448, v2
  v_add_u32 v225, v4, v5
  v_and_b32 v5, 4, v1
  v_bfe_u32 v6, v1, 1, 1
  v_and_b32 v4, 1, v1
  v_lshl_or_b32 v4, v4, 1, v5
  v_or_b32 v4, v4, v6
  v_lshlrev_b32 v5, 1, v2
  v_xor_b32 v4, v4, v5
  v_lshlrev_b32 v4, 3, v4
  v_and_b32 v5, 7, v1
  v_lshl_or_b32 v4, v5, 7, v4
  v_lshrrev_b32 v5, 3, v1
  v_mul_u32_u24 v5, 2112, v5
  s_mul_i32 s28, s3, 4224
  v_add3_u32 v226, v4, v5, s28
  v_xor_b32 v242, 8, v226
  s_lshl_b32 s28, s3, 8
  v_lshlrev_b32 v4, 21, v2
  v_lshl_add_u32 v4, v1, 4, v4
  v_add_u32 v227, s28, v4
  s_lshl_b32 s48, s2, 12
  s_add_u32 s49, s48, 524288
  s_add_u32 s50, s48, 1048576
  s_add_u32 s51, s48, 1572864
  s_cmp_lg_u32 s3, 0
  s_cbranch_scc1 Lskip_25
  v_lshl_or_b32 v4, v2, 2, 0
  v_lshl_add_u32 v4, v4, 4, v1
  v_sub_u32 v4, 256, v4
  v_and_b32 v5, 0xc0, v4
  v_and_b32 v6, 15, v4
  v_lshl_or_b32 v5, v6, 2, v5
  v_bfe_u32 v6, v4, 4, 2
  v_or_b32 v5, v5, v6
  v_lshlrev_b32 v5, 2, v5
  v_add_u32 v244, s29, v5
  v_lshl_or_b32 v4, v2, 2, 1
  v_lshl_add_u32 v4, v4, 4, v1
  v_sub_u32 v4, 256, v4
  v_and_b32 v5, 0xc0, v4
  v_and_b32 v6, 15, v4
  v_lshl_or_b32 v5, v6, 2, v5
  v_bfe_u32 v6, v4, 4, 2
  v_or_b32 v5, v5, v6
  v_lshlrev_b32 v5, 2, v5
  v_add_u32 v245, s29, v5
  v_lshl_or_b32 v4, v2, 2, 2
  v_lshl_add_u32 v4, v4, 4, v1
  v_sub_u32 v4, 256, v4
  v_and_b32 v5, 0xc0, v4
  v_and_b32 v6, 15, v4
  v_lshl_or_b32 v5, v6, 2, v5
  v_bfe_u32 v6, v4, 4, 2
  v_or_b32 v5, v5, v6
  v_lshlrev_b32 v5, 2, v5
  v_add_u32 v246, s29, v5
  v_lshl_or_b32 v4, v2, 2, 3
  v_lshl_add_u32 v4, v4, 4, v1
  v_sub_u32 v4, 256, v4
  v_and_b32 v5, 0xc0, v4
  v_and_b32 v6, 15, v4
  v_lshl_or_b32 v5, v6, 2, v5
  v_bfe_u32 v6, v4, 4, 2
  v_or_b32 v5, v5, v6
  v_lshlrev_b32 v5, 2, v5
  v_add_u32 v247, s29, v5
Lskip_25:
  s_mov_b32 s52, 100000
  s_mov_b32 s39, 10747904
  s_mov_b64 exec, 0xffff
  buffer_load_dword v14, v228, s[24:27], s39 offen sc1
  s_mov_b64 exec, -1
  s_mov_b64 exec, 0xffff
Lpoll_26:
  s_waitcnt vmcnt(0)
  v_cmp_ne_u32 vcc, s40, v14
  s_nop 0
  s_and_b64 exec, exec, vcc
  s_cbranch_scc0 Lpolldone_27
  buffer_load_dword v14, v228, s[24:27], s39 offen sc1
  s_sub_u32 s52, s52, 1
  s_cmp_lg_u32 s52, 0
  s_cbranch_scc1 Lpoll_26
  s_waitcnt vmcnt(0)
Lpolldone_27:
  s_mov_b64 exec, -1
  s_cmp_eq_u32 s3, 0
  s_cbranch_scc1 Lelse_28
  buffer_load_dwordx4 v[32:35], v224, s[24:27], 0 offen offset:0 sc1
  buffer_load_dwordx4 v[36:39], v224, s[24:27], 0 offen offset:1024 sc1
  buffer_load_dwordx4 v[40:43], v224, s[24:27], 0 offen offset:2048 sc1
  buffer_load_dwordx4 v[44:47], v224, s[24:27], 0 offen offset:3072 sc1
  s_branch Lend_29
Lelse_28:
  buffer_load_dwordx4 v[32:35], v224, s[24:27], 0 offen offset:0 sc1
  buffer_load_dword v36, v244, s[24:27], 0 offen offset:1024 sc1
  buffer_load_dword v37, v245, s[24:27], 0 offen offset:1024 sc1
  buffer_load_dword v38, v246, s[24:27], 0 offen offset:1024 sc1
  buffer_load_dword v39, v247, s[24:27], 0 offen offset:1024 sc1
  buffer_load_dwordx4 v[40:43], v224, s[24:27], 0 offen offset:2048 sc1
  buffer_load_dword v44, v244, s[24:27], 0 offen offset:3072 sc1
  buffer_load_dword v45, v245, s[24:27], 0 offen offset:3072 sc1
  buffer_load_dword v46, v246, s[24:27], 0 offen offset:3072 sc1
  buffer_load_dword v47, v247, s[24:27], 0 offen offset:3072 sc1
  s_waitcnt vmcnt(8)
  v_xor_b32 v36, 0x8000, v36
  s_waitcnt vmcnt(7)
  v_xor_b32 v37, 0x8000, v37
  s_waitcnt vmcnt(6)
  v_xor_b32 v38, 0x8000, v38
  s_waitcnt vmcnt(5)
  v_xor_b32 v39, 0x8000, v39
  s_waitcnt vmcnt(3)
  v_xor_b32 v44, 0x8000, v44
  s_waitcnt vmcnt(2)
  v_xor_b32 v45, 0x8000, v45
  s_waitcnt vmcnt(1)
  v_xor_b32 v46, 0x8000, v46
  s_waitcnt vmcnt(0)
  v_xor_b32 v47, 0x8000, v47
Lend_29:
  s_waitcnt vmcnt(0)
  v_mfma_f32_16x16x32_bf16 v[48:51], v[32:35], v[112:115], 0
  v_mfma_f32_16x16x32_bf16 v[52:55], v[32:35], v[116:119], 0
  v_mfma_f32_16x16x32_bf16 v[56:59], v[32:35], v[120:123], 0
  v_mfma_f32_16x16x32_bf16 v[60:63], v[32:35], v[124:127], 0
  v_mfma_f32_16x16x32_bf16 v[48:51], v[36:39], v[112:115], v[48:51]
  v_mfma_f32_16x16x32_bf16 v[52:55], v[36:39], v[116:119], v[52:55]
  v_mfma_f32_16x16x32_bf16 v[56:59], v[36:39], v[128:131], v[56:59]
  v_mfma_f32_16x16x32_bf16 v[60:63], v[36:39], v[132:135], v[60:63]
  v_mfma_f32_16x16x32_bf16 v[64:67], v[40:43], v[112:115], 0
  v_mfma_f32_16x16x32_bf16 v[68:71], v[40:43], v[116:119], 0
  v_mfma_f32_16x16x32_bf16 v[72:75], v[40:43], v[120:123], 0
  v_mfma_f32_16x16x32_bf16 v[76:79], v[40:43], v[124:127], 0
  v_mfma_f32_16x16x32_bf16 v[64:67], v[44:47], v[112:115], v[64:67]
  v_mfma_f32_16x16x32_bf16 v[68:71], v[44:47], v[116:119], v[68:71]
  v_mfma_f32_16x16x32_bf16 v[72:75], v[44:47], v[128:131], v[72:75]
  v_mfma_f32_16x16x32_bf16 v[76:79], v[44:47], v[132:135], v[76:79]
  v_mul_f32 v4, v48, v96
  v_mul_f32 v5, v52, v96
  v_mul_f32 v6, v49, v98
  v_mul_f32 v7, v53, v98
  v_mul_f32 v8, v50, v100
  v_mul_f32 v9, v54, v100
  v_mul_f32 v10, v51, v102
  v_mul_f32 v11, v55, v102
  v_fmac_f32 v4, v52, v97
  v_fma_f32 v5, -v48, v97, v5
  v_fmac_f32 v6, v53, v99
  v_fma_f32 v7, -v49, v99, v7
  v_fmac_f32 v8, v54, v101
  v_fma_f32 v9, -v50, v101, v9
  v_fmac_f32 v10, v55, v103
  v_fma_f32 v11, -v51, v103, v11
  v_perm_b32 v16, v5, v4, s47
  v_perm_b32 v17, v7, v6, s47
  v_perm_b32 v18, v9, v8, s47
  v_perm_b32 v19, v11, v10, s47
  v_mul_f32 v4, v56, v104
  v_mul_f32 v5, v60, v104
  v_mul_f32 v6, v57, v106
  v_mul_f32 v7, v61, v106
  v_mul_f32 v8, v58, v108
  v_mul_f32 v9, v62, v108
  v_mul_f32 v10, v59, v110
  v_mul_f32 v11, v63, v110
  v_fmac_f32 v4, v60, v105
  v_fma_f32 v5, -v56, v105, v5
  v_fmac_f32 v6, v61, v107
  v_fma_f32 v7, -v57, v107, v7
  v_fmac_f32 v8, v62, v109
  v_fma_f32 v9, -v58, v109, v9
  v_fmac_f32 v10, v63, v111
  v_fma_f32 v11, -v59, v111, v11
  v_perm_b32 v20, v5, v4, s47
  v_perm_b32 v21, v7, v6, s47
  v_perm_b32 v22, v9, v8, s47
  v_perm_b32 v23, v11, v10, s47
  v_mul_f32 v4, v64, v96
  v_mul_f32 v5, v68, v96
  v_mul_f32 v6, v65, v98
  v_mul_f32 v7, v69, v98
  v_mul_f32 v8, v66, v100
  v_mul_f32 v9, v70, v100
  v_mul_f32 v10, v67, v102
  v_mul_f32 v11, v71, v102
  v_fmac_f32 v4, v68, v97
  v_fma_f32 v5, -v64, v97, v5
  v_fmac_f32 v6, v69, v99
  v_fma_f32 v7, -v65, v99, v7
  v_fmac_f32 v8, v70, v101
  v_fma_f32 v9, -v66, v101, v9
  v_fmac_f32 v10, v71, v103
  v_fma_f32 v11, -v67, v103, v11
  v_perm_b32 v24, v5, v4, s47
  v_perm_b32 v25, v7, v6, s47
  v_perm_b32 v26, v9, v8, s47
  v_perm_b32 v27, v11, v10, s47
  v_mul_f32 v4, v72, v104
  v_mul_f32 v5, v76, v104
  v_mul_f32 v6, v73, v106
  v_mul_f32 v7, v77, v106
  v_mul_f32 v8, v74, v108
  v_mul_f32 v9, v78, v108
  v_mul_f32 v10, v75, v110
  v_mul_f32 v11, v79, v110
  v_fmac_f32 v4, v76, v105
  v_fma_f32 v5, -v72, v105, v5
  v_fmac_f32 v6, v77, v107
  v_fma_f32 v7, -v73, v107, v7
  v_fmac_f32 v8, v78, v109
  v_fma_f32 v9, -v74, v109, v9
  v_fmac_f32 v10, v79, v111
  v_fma_f32 v11, -v75, v111, v11
  v_perm_b32 v28, v5, v4, s47
  v_perm_b32 v29, v7, v6, s47
  v_perm_b32 v30, v9, v8, s47
  v_perm_b32 v31, v11, v10, s47
  v_mfma_f32_16x16x32_bf16 v[48:51], v[88:91], v[16:19], 0
  v_mfma_f32_16x16x32_bf16 v[52:55], v[92:95], v[16:19], 0
  v_mfma_f32_16x16x32_bf16 v[64:67], v[88:91], v[24:27], 0
  v_mfma_f32_16x16x32_bf16 v[68:71], v[92:95], v[24:27], 0
  v_mfma_f32_16x16x32_bf16 v[56:59], v[88:91], v[20:23], 0
  v_mfma_f32_16x16x32_bf16 v[60:63], v[92:95], v[20:23], 0
  v_mfma_f32_16x16x32_bf16 v[72:75], v[88:91], v[28:31], 0
  v_mfma_f32_16x16x32_bf16 v[76:79], v[92:95], v[28:31], 0
  s_nop 1
  v_perm_b32 v32, v52, v48, s47
  s_nop 0
  v_perm_b32 v33, v68, v64, s47
  ds_write_b64 v225, v[32:33] offset:0
  v_perm_b32 v34, v53, v49, s47
  v_perm_b32 v35, v69, v65, s47
  ds_write_b64 v225, v[34:35] offset:2112
  v_perm_b32 v36, v54, v50, s47
  v_perm_b32 v37, v70, v66, s47
  ds_write_b64 v225, v[36:37] offset:4224
  v_perm_b32 v38, v55, v51, s47
  v_perm_b32 v39, v71, v67, s47
  ds_write_b64 v225, v[38:39] offset:6336
  v_perm_b32 v40, v60, v56, s47
  v_perm_b32 v41, v76, v72, s47
  ds_write_b64 v225, v[40:41] offset:1024
  v_perm_b32 v42, v61, v57, s47
  v_perm_b32 v43, v77, v73, s47
  ds_write_b64 v225, v[42:43] offset:3136
  v_perm_b32 v44, v62, v58, s47
  v_perm_b32 v45, v78, v74, s47
  ds_write_b64 v225, v[44:45] offset:5248
  v_perm_b32 v46, v63, v59, s47
  v_perm_b32 v47, v79, v75, s47
  ds_write_b64 v225, v[46:47] offset:7360
  s_waitcnt lgkmcnt(0)
  s_barrier
  ds_read_b64 v[16:17], v226 offset:0
  ds_read_b64 v[18:19], v242 offset:0
  ds_read_b64 v[20:21], v226 offset:1024
  ds_read_b64 v[22:23], v242 offset:1024
  ds_read_b64 v[24:25], v226 offset:64
  ds_read_b64 v[26:27], v242 offset:64
  ds_read_b64 v[28:29], v226 offset:1088
  ds_read_b64 v[30:31], v242 offset:1088
  s_waitcnt lgkmcnt(6)
  v_mfma_f32_16x16x32_bf16 v[48:51], v[80:83], v[16:19], 0
  v_mfma_f32_16x16x32_bf16 v[52:55], v[84:87], v[16:19], 0
  s_waitcnt lgkmcnt(4)
  v_mfma_f32_16x16x32_bf16 v[56:59], v[80:83], v[20:23], 0
  v_mfma_f32_16x16x32_bf16 v[60:63], v[84:87], v[20:23], 0
  s_waitcnt lgkmcnt(2)
  v_mfma_f32_16x16x32_bf16 v[64:67], v[80:83], v[24:27], 0
  v_mfma_f32_16x16x32_bf16 v[68:71], v[84:87], v[24:27], 0
  s_waitcnt lgkmcnt(0)
  v_mfma_f32_16x16x32_bf16 v[72:75], v[80:83], v[28:31], 0
  v_mfma_f32_16x16x32_bf16 v[76:79], v[84:87], v[28:31], 0
  v_cvt_pk_bf16_f32 v32, v48, v52
  s_nop 0
  v_cvt_pk_bf16_f32 v33, v56, v60
  s_nop 1
  v_cvt_pk_bf16_f32 v34, v64, v68
  s_nop 1
  v_cvt_pk_bf16_f32 v35, v72, v76
  buffer_store_dwordx4 v[32:35], v227, s[20:23], s48 offen nt
  v_cvt_pk_bf16_f32 v36, v49, v53
  v_cvt_pk_bf16_f32 v37, v57, v61
  v_cvt_pk_bf16_f32 v38, v65, v69
  v_cvt_pk_bf16_f32 v39, v73, v77
  buffer_store_dwordx4 v[36:39], v227, s[20:23], s49 offen nt
  v_cvt_pk_bf16_f32 v40, v50, v54
  v_cvt_pk_bf16_f32 v41, v58, v62
  v_cvt_pk_bf16_f32 v42, v66, v70
  v_cvt_pk_bf16_f32 v43, v74, v78
  buffer_store_dwordx4 v[40:43], v227, s[20:23], s50 offen nt
  v_cvt_pk_bf16_f32 v44, v51, v55
  v_cvt_pk_bf16_f32 v45, v59, v63
  v_cvt_pk_bf16_f32 v46, v67, v71
  v_cvt_pk_bf16_f32 v47, v75, v79
  buffer_store_dwordx4 v[44:47], v227, s[20:23], s51 offen nt
  s_endpgm
L_A_end:
L_B_body:
  v_lshlrev_b32 v238, 3, v9
  v_add_u32 v238, 117760, v238
  s_mul_i32 s28, s3, 4608
  s_add_u32 s28, s28, 117248
  v_lshl_add_u32 v239, v1, 3, s28
  v_lshlrev_b32 v5, 4, v3
  v_lshl_add_u32 v5, v2, 5, v5
  v_add_u32 v241, s28, v5
  v_mov_b32 v6, 0
  v_mov_b32 v7, 0
  ds_write_b64 v239, v[6:7]
  v_mov_b32 v247, 154112
  v_mov_b32 v253, 1
  ds_write_b64 v247, v[6:7]
  ds_write_b32 v247, v6 offset:8
  s_mul_i32 s28, s3, 14656
  s_mov_b32 m0, s28
  v_lshrrev_b32 v6, 5, v1
  v_lshl_add_u32 v7, v6, 4, s28
  v_mul_u32_u24 v233, 272, v4
  v_add_u32 v233, v233, v7
  v_and_b32 v8, 7, v1
  v_or_b32 v8, 0x0c0c0c00, v8
  s_mov_b32 s29, 0x252b3434
  v_mov_b32 v10, 0x23222120
  v_perm_b32 v11, s29, v10, v8
  s_mov_b32 s29, 0x24242525
  v_mov_b32 v10, 0x33323130
  v_perm_b32 v12, s29, v10, v8
  s_mov_b32 s29, 0x27292928
  v_mov_b32 v10, 0x262d2d2c
  v_perm_b32 v13, s29, v10, v8
  s_mov_b32 s29, 0x2f2f2e27
  v_mov_b32 v10, 0x2a2a2a26
  v_perm_b32 v14, s29, v10, v8
  v_and_b32 v9, 8, v1
  v_cmp_eq_u32 vcc, 0, v9
  v_and_b32 v9, 16, v1
  s_nop 0
  v_cndmask_b32 v11, v12, v11, vcc
  v_cndmask_b32 v13, v14, v13, vcc
  v_cmp_eq_u32 vcc, 0, v9
  v_and_b32 v8, 3, v1
  s_nop 0
  v_cndmask_b32 v9, v13, v11, vcc
  v_mul_u32_u24 v232, 272, v9
  v_add_u32 v232, v232, v7
  s_add_u32 s28, s28, 64
  v_lshlrev_b32 v9, 9, v6
  v_lshl_add_u32 v9, v4, 4, v9
  v_add_u32 v234, s28, v9
  v_mul_u32_u24 v9, 1216, v3
  v_lshl_add_u32 v9, v2, 2, v9
  v_add_u32 v235, s28, v9
  v_bfe_u32 v10, v1, 2, 2
  v_mul_u32_u24 v9, 1216, v10
  v_lshl_add_u32 v9, v8, 3, v9
  v_lshlrev_b32 v11, 4, v3
  v_sub_u32 v9, v9, v11
  v_add_u32 v240, s28, v9
  s_add_u32 s28, s28, 4864
  v_mul_u32_u24 v9, 192, v3
  v_lshl_add_u32 v9, v2, 2, v9
  v_add_u32 v228, s28, v9
  v_mul_u32_u24 v9, 192, v10
  v_lshl_add_u32 v9, v8, 3, v9
  v_lshlrev_b32 v11, 3, v3
  v_sub_u32 v9, v9, v11
  v_sub_u32 v11, v9, v11
  v_add_u32 v226, s28, v11
  s_add_u32 s28, s28, 768
  v_add_u32 v242, s28, v9
  v_lshrrev_b32 v9, 3, v1
  v_mul_u32_u24 v9, 192, v9
  v_and_b32 v11, 7, v1
  v_lshl_add_u32 v9, v11, 4, v9
  v_add_u32 v236, s28, v9
  v_lshlrev_b32 v9, 5, v6
  v_and_b32 v11, 30, v1
  v_add3_u32 v9, v9, v11, s28
  v_and_b32 v11, 1, v1
  v_mul_u32_u24 v12, 1536, v11
  v_add_u32 v230, v9, v12
  v_lshlrev_b32 v11, 6, v11
  v_sub_u32 v237, v9, v11
  s_add_u32 s28, s28, 4608
  v_lshrrev_b32 v11, 2, v2
  v_xor_b32 v11, v11, v3
  v_lshlrev_b32 v9, 5, v2
  v_lshl_add_u32 v9, v11, 3, v9
  v_add_u32 v243, s28, v9
  s_mov_b32 s28, 10304
  v_mul_u32_u24 v9, 14656, v10
  v_lshl_add_u32 v9, v8, 3, v9
  v_lshl_add_u32 v9, v3, 5, v9
  v_add_u32 v244, s28, v9
  s_lshl_b32 s28, s56, 1
  s_add_u32 s28, s28, 2048
  v_lshl_add_u32 v245, v1, 12, s28
  s_mov_b32 s57, 0x05040100
  s_mov_b32 s58, 0x07060302
  v_lshlrev_b32 v9, 1, v2
  v_sub_u32 v9, v9, v3
  v_mov_b32 v11, 0xffff
  v_cmp_ge_i32 vcc, 2, v9
  s_nop 1
  v_cndmask_b32 v246, 0, v11, vcc
  v_cmp_ge_i32 vcc, 1, v9
  s_nop 1
  v_cndmask_b32 v246, v246, -1, vcc
  v_cmp_eq_u32 vcc, 4, v9
  s_nop 1
  v_cndmask_b32 v229, 0, v11, vcc
  v_cmp_eq_u32 vcc, 3, v9
  s_nop 1
  v_cndmask_b32 v229, v229, -1, vcc
  v_mov_b32 v11, 0xffff0000
  v_cmp_eq_u32 vcc, 2, v9
  s_nop 1
  v_cndmask_b32 v229, v229, v11, vcc
  v_lshlrev_b32 v225, 4, v1
  v_add_u32 v225, 154176, v225
  s_cmp_lt_u32 s3, 3
  s_cbranch_scc1 Lskip_1002
  s_lshl_b32 s28, s3, 2
  s_lshr_b32 s29, 0x33579000, s28
  s_and_b32 s29, s29, 15
  s_bfm_b32 s29, s29, 0
  s_lshr_b32 s30, 0x3b654000, s28
  s_and_b32 s30, s30, 15
  s_lshl_b32 s29, s29, s30
  v_lshlrev_b32 v9, v2, s29
  v_lshlrev_b32 v11, 3, v3
  v_lshrrev_b32 v9, v11, v9
  s_sub_u32 s28, s3, 3
  s_lshl_b32 s28, s28, 10
  v_add_u32 v10, s28, v225
  v_bfe_i32 v11, v9, 0, 1
  v_bfe_i32 v12, v9, 1, 1
  v_and_b32 v11, 0x3f80, v11
  v_and_b32 v12, 0x3f800000, v12
  v_or_b32 v192, v11, v12
  v_bfe_i32 v11, v9, 2, 1
  v_bfe_i32 v12, v9, 3, 1
  v_and_b32 v11, 0x3f80, v11
  v_and_b32 v12, 0x3f800000, v12
  v_or_b32 v193, v11, v12
  v_bfe_i32 v11, v9, 4, 1
  v_bfe_i32 v12, v9, 5, 1
  v_and_b32 v11, 0x3f80, v11
  v_and_b32 v12, 0x3f800000, v12
  v_or_b32 v194, v11, v12
  v_bfe_i32 v11, v9, 6, 1
  v_bfe_i32 v12, v9, 7, 1
  v_and_b32 v11, 0x3f80, v11
  v_and_b32 v12, 0x3f800000, v12
  v_or_b32 v195, v11, v12
  ds_write_b128 v10, v[192:195]
Lskip_1002:
  s_cmp_gt_u32 s3, 3
  s_cbranch_scc1 Lskip_1003
  s_waitcnt vmcnt(0)
Lskip_1003:
  s_cbranch_scc0 Lskip_1004
  s_waitcnt vmcnt(0)
Lskip_1004:
  v_mul_f32 v5, 0x3fb8aa3b, v38
  v_mov_b32 v7, 0x3fb8aa3b
  v_fma_f32 v6, v38, v7, -v5
  v_fmamk_f32 v6, v38, 0x32a57060, v6
  v_exp_f32 v5, v5
  v_mul_f32 v6, 0x3f317218, v6
  v_fmac_f32 v5, v5, v6
  v_cvt_pk_bf16_f32 v5, v5, v5
  v_and_b32 v248, 0xffff0000, v5
  v_mov_b32 v249, v249
  s_cmp_lt_u32 s3, 4
  s_cbranch_scc1 Lskip_1005
  s_setprio 1
Lskip_1005:
  s_cmp_gt_u32 s3, 3
  s_cbranch_scc1 Lskip_1006
  buffer_load_dwordx4 v[176:179], v252, s[8:11], 0 offen offset:0
Lskip_1006:
  v_lshlrev_b32 v56, 16, v32
  v_lshlrev_b32 v57, 16, v33
  v_mul_f32 v56, v248, v56
  v_mul_f32 v57, v248, v57
  v_mul_f32 v56, 0x3fb8aa3b, v56
  v_mul_f32 v57, 0x3e22f983, v57
  v_mul_f32 v62, 0x41000000, v56
  v_mul_f32 v63, 0x41000000, v57
  v_mul_f32 v65, 0x43000000, v56
  v_mul_f32 v66, 0x43000000, v57
  v_mul_f32 v71, 0x43800000, v56
  v_mul_f32 v72, 0x43800000, v57
  v_fract_f32 v63, v63
  v_fract_f32 v66, v66
  v_fract_f32 v69, v57
  v_fract_f32 v72, v72
  v_exp_f32 v62, v62
  v_exp_f32 v65, v65
  v_exp_f32 v68, v56
  v_exp_f32 v71, v71
  v_cos_f32 v128, v63
  v_sin_f32 v129, v63
  v_cos_f32 v130, v66
  v_sin_f32 v131, v66
  v_cos_f32 v126, v69
  v_sin_f32 v127, v69
  v_cos_f32 v132, v72
  v_sin_f32 v133, v72
  v_mul_f32 v65, 0x3f805c68, v65
  v_mul_f32 v128, v128, v62
  v_mul_f32 v129, v129, v62
  v_mul_f32 v130, v130, v65
  v_mul_f32 v131, v131, v65
  v_mul_f32 v126, v126, v68
  v_mul_f32 v127, v127, v68
  v_mul_f32 v132, v132, v71
  v_mul_f32 v133, v133, v71
  v_lshlrev_b32 v58, 16, v34
  v_lshlrev_b32 v59, 16, v35
  v_lshlrev_b32 v60, 16, v36
  v_lshlrev_b32 v61, 16, v37
  v_mul_f32 v58, v248, v58
  v_mul_f32 v59, v248, v59
  v_mul_f32 v138, v60, v58
  v_mul_f32 v139, v60, v59
  v_fma_f32 v138, -v61, v59, v138
  v_fmac_f32 v139, v61, v58
  v_mul_f32 v138, 0x3f805c68, v138
  v_mul_f32 v139, 0xbf805c68, v139
  v_perm_b32 v10, v139, v138, s58
  ds_write_addtid_b32 v10 offset:8704
  v_mul_f32 v134, v126, v126
  v_add_f32 v135, v126, v126
  v_fma_f32 v134, -v127, v127, v134
  v_mul_f32 v135, v135, v127
  v_mul_f32 v136, v134, v134
  v_add_f32 v137, v134, v134
  v_fma_f32 v136, -v135, v135, v136
  v_mul_f32 v137, v137, v135
  v_perm_b32 v8, v131, v130, s58
  v_mov_b32 v6, 0x3f80
  ds_write_addtid_b32 v8 offset:4352
  ds_write_addtid_b32 v6 offset:0
  v_mul_f32 v142, 0x3f805c68, v128
  v_mul_f32 v143, 0x3f805c68, v129
  v_perm_b32 v5, v143, v142, s58
  ds_write_addtid_b32 v5 offset:272
  v_mul_f32 v146, v130, v128
  v_mul_f32 v140, v142, v128
  v_mul_f32 v147, v130, v129
  v_mul_f32 v141, v142, v129
  v_fma_f32 v146, -v131, v129, v146
  v_fma_f32 v140, -v143, v129, v140
  v_fmac_f32 v147, v131, v128
  v_fmac_f32 v141, v143, v128
  v_perm_b32 v7, v147, v146, s58
  v_perm_b32 v6, v141, v140, s58
  ds_write_addtid_b32 v7 offset:4624
  ds_write_addtid_b32 v6 offset:544
  v_mul_f32 v144, v146, v128
  v_mul_f32 v142, v140, v128
  v_mul_f32 v145, v146, v129
  v_mul_f32 v143, v140, v129
  v_fma_f32 v144, -v147, v129, v144
  v_fma_f32 v142, -v141, v129, v142
  v_fmac_f32 v145, v147, v128
  v_fmac_f32 v143, v141, v128
  v_perm_b32 v8, v145, v144, s58
  v_perm_b32 v5, v143, v142, s58
  ds_write_addtid_b32 v8 offset:4896
  ds_write_addtid_b32 v5 offset:816
  v_mul_f32 v146, v144, v128
  v_mul_f32 v122, v138, v132
  v_mul_f32 v147, v144, v129
  v_mul_f32 v123, v139, v132
  v_fma_f32 v146, -v145, v129, v146
  v_fmac_f32 v122, v139, v133
  v_fmac_f32 v147, v145, v128
  v_fma_f32 v123, -v138, v133, v123
  v_perm_b32 v7, v147, v146, s58
  v_perm_b32 v12, v123, v122, s58
  ds_write_addtid_b32 v7 offset:5168
  ds_write_addtid_b32 v12 offset:14144
  v_mul_f32 v140, v142, v128
  v_mul_f32 v144, v146, v128
  v_mul_f32 v141, v142, v129
  v_mul_f32 v145, v146, v129
  v_fma_f32 v140, -v143, v129, v140
  v_fma_f32 v144, -v147, v129, v144
  s_cmp_gt_u32 s3, 3
  s_cbranch_scc1 Lskip_1007
  buffer_load_dwordx4 v[180:183], v252, s[8:11], 0 offen offset:2048
Lskip_1007:
  v_fmac_f32 v141, v143, v128
  v_fmac_f32 v145, v147, v128
  v_perm_b32 v6, v141, v140, s58
  v_perm_b32 v8, v145, v144, s58
  ds_write_addtid_b32 v6 offset:1088
  ds_write_addtid_b32 v8 offset:5440
  v_mul_f32 v124, v122, v134
  v_mul_f32 v142, v140, v128
  v_mul_f32 v125, v123, v134
  v_mul_f32 v143, v140, v129
  v_fmac_f32 v124, v123, v135
  v_fma_f32 v142, -v141, v129, v142
  v_fma_f32 v125, -v122, v135, v125
  v_fmac_f32 v143, v141, v128
  v_perm_b32 v11, v125, v124, s58
  v_perm_b32 v5, v143, v142, s58
  ds_write_addtid_b32 v11 offset:11696
  ds_write_addtid_b32 v5 offset:1360
  v_mul_f32 v146, v144, v128
  v_mul_f32 v152, v124, v134
  v_mul_f32 v147, v144, v129
  v_mul_f32 v153, v125, v134
  v_fma_f32 v146, -v145, v129, v146
  v_fmac_f32 v152, v125, v135
  v_fmac_f32 v147, v145, v128
  v_fma_f32 v153, -v124, v135, v153
  v_perm_b32 v7, v147, v146, s58
  v_perm_b32 v12, v153, v152, s58
  ds_write_addtid_b32 v7 offset:5712
  ds_write_addtid_b32 v12 offset:10064
  v_mul_f32 v140, v142, v128
  v_mul_f32 v144, v146, v128
  v_mul_f32 v141, v142, v129
  v_mul_f32 v145, v146, v129
  v_fma_f32 v140, -v143, v129, v140
  v_fma_f32 v144, -v147, v129, v144
  v_fmac_f32 v141, v143, v128
  v_fmac_f32 v145, v147, v128
  v_perm_b32 v6, v141, v140, s58
  v_perm_b32 v8, v145, v144, s58
  ds_write_addtid_b32 v6 offset:1632
  ds_write_addtid_b32 v8 offset:5984
  v_mul_f32 v124, v152, v134
  v_mul_f32 v142, v140, v128
  v_mul_f32 v125, v153, v134
  v_mul_f32 v143, v140, v129
  v_fmac_f32 v124, v153, v135
  v_fma_f32 v142, -v141, v129, v142
  v_fma_f32 v125, -v152, v135, v125
  v_fmac_f32 v143, v141, v128
  v_perm_b32 v11, v125, v124, s58
  v_perm_b32 v5, v143, v142, s58
  ds_write_addtid_b32 v11 offset:9792
  ds_write_addtid_b32 v5 offset:1904
  v_mul_f32 v146, v144, v128
  v_mul_f32 v120, v122, v132
  v_mul_f32 v147, v144, v129
  v_mul_f32 v121, v123, v132
  v_fma_f32 v146, -v145, v129, v146
  v_fmac_f32 v120, v123, v133
  v_fmac_f32 v147, v145, v128
  v_fma_f32 v121, -v122, v133, v121
  v_perm_b32 v7, v147, v146, s58
  v_perm_b32 v12, v121, v120, s58
  ds_write_addtid_b32 v7 offset:6256
  ds_write_addtid_b32 v12 offset:11968
  v_mul_f32 v140, v142, v128
  v_mul_f32 v144, v146, v128
  v_mul_f32 v141, v142, v129
  v_mul_f32 v145, v146, v129
  v_fma_f32 v140, -v143, v129, v140
  v_fma_f32 v144, -v147, v129, v144
  v_fmac_f32 v141, v143, v128
  v_fmac_f32 v145, v147, v128
  v_perm_b32 v6, v141, v140, s58
  v_perm_b32 v8, v145, v144, s58
  ds_write_addtid_b32 v6 offset:2176
  ds_write_addtid_b32 v8 offset:6528
  v_mul_f32 v124, v120, v136
  v_mul_f32 v142, v140, v128
  v_mul_f32 v125, v121, v136
  v_mul_f32 v143, v140, v129
  v_fmac_f32 v124, v121, v137
  v_fma_f32 v142, -v141, v129, v142
  v_fma_f32 v125, -v120, v137, v125
  v_fmac_f32 v143, v141, v128
  v_perm_b32 v11, v125, v124, s58
  v_perm_b32 v5, v143, v142, s58
  ds_write_addtid_b32 v11 offset:12240
  ds_write_addtid_b32 v5 offset:2448
  v_mul_f32 v146, v144, v128
  v_mul_f32 v150, v138, v126
  v_mul_f32 v147, v144, v129
  v_mul_f32 v151, v139, v126
  v_fma_f32 v146, -v145, v129, v146
  v_fmac_f32 v150, v139, v127
  v_fmac_f32 v147, v145, v128
  v_fma_f32 v151, -v138, v127, v151
  v_perm_b32 v7, v147, v146, s58
  v_perm_b32 v9, v151, v150, s58
  ds_write_addtid_b32 v7 offset:6800
  ds_write_addtid_b32 v9 offset:8976
  v_mul_f32 v122, v120, v132
  v_mul_f32 v140, v142, v128
  v_mul_f32 v123, v121, v132
  v_mul_f32 v141, v142, v129
  v_fmac_f32 v122, v121, v133
  v_fma_f32 v140, -v143, v129, v140
  v_fma_f32 v123, -v120, v133, v123
  v_fmac_f32 v141, v143, v128
  s_cmp_gt_u32 s3, 3
  s_cbranch_scc1 Lskip_1008
  buffer_load_dwordx4 v[184:187], v252, s[8:11], s36 offen offset:0
Lskip_1008:
  v_perm_b32 v12, v123, v122, s58
  v_perm_b32 v6, v141, v140, s58
  ds_write_addtid_b32 v12 offset:10880
  ds_write_addtid_b32 v6 offset:2720
  v_mul_f32 v144, v146, v128
  v_mul_f32 v148, v150, v126
  v_mul_f32 v145, v146, v129
  v_mul_f32 v149, v151, v126
  v_fma_f32 v144, -v147, v129, v144
  v_fmac_f32 v148, v151, v127
  v_fmac_f32 v145, v147, v128
  v_fma_f32 v149, -v150, v127, v149
  v_perm_b32 v8, v145, v144, s58
  v_perm_b32 v10, v149, v148, s58
  ds_write_addtid_b32 v8 offset:7072
  ds_write_addtid_b32 v10 offset:9248
  v_mul_f32 v124, v122, v136
  v_mul_f32 v142, v140, v128
  v_mul_f32 v125, v123, v136
  v_mul_f32 v143, v140, v129
  v_fmac_f32 v124, v123, v137
  v_fma_f32 v142, -v141, v129, v142
  v_fma_f32 v125, -v122, v137, v125
  v_fmac_f32 v143, v141, v128
  v_perm_b32 v11, v125, v124, s58
  v_perm_b32 v5, v143, v142, s58
  ds_write_addtid_b32 v11 offset:11152
  ds_write_addtid_b32 v5 offset:2992
  v_mul_f32 v146, v144, v128
  v_mul_f32 v150, v148, v126
  v_mul_f32 v147, v144, v129
  v_mul_f32 v151, v149, v126
  v_fma_f32 v146, -v145, v129, v146
  v_fmac_f32 v150, v149, v127
  v_fmac_f32 v147, v145, v128
  v_fma_f32 v151, -v148, v127, v151
  v_perm_b32 v7, v147, v146, s58
  v_perm_b32 v9, v151, v150, s58
  ds_write_addtid_b32 v7 offset:7344
  ds_write_addtid_b32 v9 offset:9520
  v_mul_f32 v120, v122, v132
  v_mul_f32 v140, v142, v128
  v_mul_f32 v121, v123, v132
  v_mul_f32 v141, v142, v129
  v_fmac_f32 v120, v123, v133
  v_fma_f32 v140, -v143, v129, v140
  v_fma_f32 v121, -v122, v133, v121
  v_fmac_f32 v141, v143, v128
  v_perm_b32 v12, v121, v120, s58
  v_perm_b32 v6, v141, v140, s58
  ds_write_addtid_b32 v12 offset:10336
  ds_write_addtid_b32 v6 offset:3264
  v_mul_f32 v144, v146, v128
  v_mul_f32 v148, v150, v126
  v_mul_f32 v145, v146, v129
  v_mul_f32 v149, v151, v126
  v_fma_f32 v144, -v147, v129, v144
  v_fmac_f32 v148, v151, v127
  v_fmac_f32 v145, v147, v128
  v_fma_f32 v149, -v150, v127, v149
  v_perm_b32 v8, v145, v144, s58
  v_perm_b32 v10, v149, v148, s58
  ds_write_addtid_b32 v8 offset:7616
  ds_write_addtid_b32 v10 offset:13056
  v_mul_f32 v122, v120, v132
  v_mul_f32 v142, v140, v128
  v_mul_f32 v123, v121, v132
  v_mul_f32 v143, v140, v129
  v_fmac_f32 v122, v121, v133
  v_fma_f32 v142, -v141, v129, v142
  v_fma_f32 v123, -v120, v133, v123
  v_fmac_f32 v143, v141, v128
  v_perm_b32 v11, v123, v122, s58
  v_perm_b32 v5, v143, v142, s58
  ds_write_addtid_b32 v11 offset:10608
  ds_write_addtid_b32 v5 offset:3536
  v_mul_f32 v146, v144, v128
  v_mul_f32 v150, v148, v126
  v_mul_f32 v147, v144, v129
  v_mul_f32 v151, v149, v126
  v_fma_f32 v146, -v145, v129, v146
  v_fmac_f32 v150, v149, v127
  v_fmac_f32 v147, v145, v128
  v_fma_f32 v151, -v148, v127, v151
  v_perm_b32 v7, v147, v146, s58
  v_perm_b32 v9, v151, v150, s58
  ds_write_addtid_b32 v7 offset:7888
  ds_write_addtid_b32 v9 offset:13328
  v_mul_f32 v120, v122, v132
  v_mul_f32 v140, v142, v128
  v_mul_f32 v121, v123, v132
  v_mul_f32 v141, v142, v129
  v_fmac_f32 v120, v123, v133
  v_fma_f32 v140, -v143, v129, v140
  v_fma_f32 v121, -v122, v133, v121
  v_fmac_f32 v141, v143, v128
  v_perm_b32 v12, v121, v120, s58
  v_perm_b32 v6, v141, v140, s58
  ds_write_addtid_b32 v12 offset:11424
  ds_write_addtid_b32 v6 offset:3808
  v_mul_f32 v144, v146, v128
  v_mul_f32 v148, v150, v126
  v_mul_f32 v145, v146, v129
  v_mul_f32 v149, v151, v126
  v_fma_f32 v144, -v147, v129, v144
  v_fmac_f32 v148, v151, v127
  v_fmac_f32 v145, v147, v128
  v_fma_f32 v149, -v150, v127, v149
  v_perm_b32 v8, v145, v144, s58
  v_perm_b32 v10, v149, v148, s58
  s_cmp_gt_u32 s3, 3
  s_cbranch_scc1 Lskip_1009
  buffer_load_dwordx4 v[188:191], v252, s[8:11], s36 offen offset:2048
Lskip_1009:
  ds_write_addtid_b32 v8 offset:8160
  ds_write_addtid_b32 v10 offset:13600
  v_mul_f32 v122, v120, v132
  v_mul_f32 v142, v140, v128
  v_mul_f32 v123, v121, v132
  v_mul_f32 v143, v140, v129
  v_fmac_f32 v122, v121, v133
  v_fma_f32 v142, -v141, v129, v142
  v_fma_f32 v123, -v120, v133, v123
  v_fmac_f32 v143, v141, v128
  v_perm_b32 v11, v123, v122, s58
  v_perm_b32 v5, v143, v142, s58
  ds_write_addtid_b32 v11 offset:12512
  ds_write_addtid_b32 v5 offset:4080
  v_mul_f32 v146, v144, v128
  v_mul_f32 v150, v148, v126
  v_mul_f32 v147, v144, v129
  v_mul_f32 v151, v149, v126
  v_fma_f32 v146, -v145, v129, v146
  v_fmac_f32 v150, v149, v127
  v_fmac_f32 v147, v145, v128
  v_fma_f32 v151, -v148, v127, v151
  v_perm_b32 v7, v147, v146, s58
  v_perm_b32 v9, v151, v150, s58
  ds_write_addtid_b32 v7 offset:8432
  ds_write_addtid_b32 v9 offset:13872
  v_mul_f32 v124, v122, v128
  v_mul_f32 v125, v123, v128
  v_fmac_f32 v124, v123, v129
  v_fma_f32 v125, -v122, v129, v125
  v_perm_b32 v12, v125, v124, s58
  ds_write_addtid_b32 v12 offset:12784
  ds_read_b128 v[56:59], v232 offset:0
  ds_read_b128 v[60:63], v233 offset:0
  ds_read_b128 v[64:67], v232 offset:32
  ds_read_b128 v[68:71], v233 offset:32
  ds_read_b128 v[72:75], v232 offset:64
  ds_read_b128 v[76:79], v233 offset:64
  ds_read_b128 v[80:83], v232 offset:96
  ds_read_b128 v[84:87], v233 offset:96
  ds_read_b128 v[88:91], v232 offset:128
  ds_read_b128 v[92:95], v233 offset:128
  ds_read_b128 v[96:99], v232 offset:160
  ds_read_b128 v[100:103], v233 offset:160
  ds_read_b128 v[104:107], v232 offset:192
  ds_read_b128 v[108:111], v233 offset:192
  ds_read_b128 v[112:115], v232 offset:224
  ds_read_b128 v[116:119], v233 offset:224
  v_and_b32 v192, 0xffff0000, v32
  v_and_b32 v193, 0xffff0000, v33
  v_mul_f32 v192, v248, v192
  v_mul_f32 v193, v248, v193
  v_mul_f32 v192, 0x3fb8aa3b, v192
  v_mul_f32 v193, 0x3e22f983, v193
  v_mul_f32 v198, 0x41000000, v192
  v_mul_f32 v199, 0x41000000, v193
  v_mul_f32 v201, 0x43000000, v192
  v_mul_f32 v202, 0x43000000, v193
  v_mul_f32 v207, 0x43800000, v192
  v_mul_f32 v208, 0x43800000, v193
  v_fract_f32 v199, v199
  v_fract_f32 v202, v202
  s_waitcnt lgkmcnt(14)
  v_mfma_f32_32x32x16_bf16 v[40:55], v[56:59], v[60:63], 0
  v_fract_f32 v205, v193
  v_fract_f32 v208, v208
  s_waitcnt lgkmcnt(12)
  v_mfma_f32_32x32x16_bf16 v[40:55], v[64:67], v[68:71], v[40:55]
  v_exp_f32 v198, v198
  v_exp_f32 v201, v201
  s_waitcnt lgkmcnt(10)
  v_mfma_f32_32x32x16_bf16 v[40:55], v[72:75], v[76:79], v[40:55]
  v_exp_f32 v204, v192
  v_exp_f32 v207, v207
  s_waitcnt lgkmcnt(8)
  v_mfma_f32_32x32x16_bf16 v[40:55], v[80:83], v[84:87], v[40:55]
  v_cos_f32 v162, v199
  v_sin_f32 v163, v199
  s_waitcnt lgkmcnt(6)
  v_mfma_f32_32x32x16_bf16 v[40:55], v[88:91], v[92:95], v[40:55]
  v_cos_f32 v164, v202
  v_sin_f32 v165, v202
  s_waitcnt lgkmcnt(4)
  v_mfma_f32_32x32x16_bf16 v[40:55], v[96:99], v[100:103], v[40:55]
  v_cos_f32 v160, v205
  v_sin_f32 v161, v205
  s_waitcnt lgkmcnt(2)
  v_mfma_f32_32x32x16_bf16 v[40:55], v[104:107], v[108:111], v[40:55]
  v_cos_f32 v166, v208
  v_sin_f32 v167, v208
  s_waitcnt lgkmcnt(0)
  v_mfma_f32_32x32x16_bf16 v[40:55], v[112:115], v[116:119], v[40:55]
  v_mul_f32 v201, 0x3f805c68, v201
  v_mul_f32 v162, v162, v198
  v_mul_f32 v163, v163, v198
  v_mul_f32 v164, v164, v201
  v_mul_f32 v165, v165, v201
  v_mul_f32 v160, v160, v204
  v_mul_f32 v161, v161, v204
  v_mul_f32 v166, v166, v207
  v_mul_f32 v167, v167, v207
  v_and_b32 v194, 0xffff0000, v34
  v_and_b32 v195, 0xffff0000, v35
  v_and_b32 v196, 0xffff0000, v36
  v_and_b32 v197, 0xffff0000, v37
  v_mul_f32 v194, v248, v194
  v_mul_f32 v195, v248, v195
  v_mul_f32 v172, v196, v194
  v_mul_f32 v173, v196, v195
  v_fma_f32 v172, -v197, v195, v172
  v_fmac_f32 v173, v197, v194
  v_mul_f32 v172, 0x3f805c68, v172
  v_mul_f32 v173, 0xbf805c68, v173
  v_perm_b32 v10, v173, v172, s58
  ds_write_addtid_b32 v10 offset:8704
  v_mul_f32 v168, v160, v160
  v_add_f32 v169, v160, v160
  v_fma_f32 v168, -v161, v161, v168
  v_mul_f32 v169, v169, v161
  v_mul_f32 v170, v168, v168
  v_add_f32 v171, v168, v168
  v_fma_f32 v170, -v169, v169, v170
  v_mul_f32 v171, v171, v169
  v_perm_b32 v8, v165, v164, s58
  v_mov_b32 v6, 0x3f80
  ds_write_addtid_b32 v8 offset:4352
  ds_write_addtid_b32 v6 offset:0
  v_mul_f32 v142, 0x3f805c68, v162
  v_mul_f32 v143, 0x3f805c68, v163
  v_perm_b32 v5, v143, v142, s58
  ds_write_addtid_b32 v5 offset:272
  v_mul_f32 v146, v164, v162
  v_mul_f32 v140, v142, v162
  s_cmp_gt_u32 s3, 3
  s_cbranch_scc1 Lskip_1010
  buffer_load_dwordx4 v[16:19], v252, s[8:11], s59 offen offset:0
Lskip_1010:
  v_mul_f32 v147, v164, v163
  v_mul_f32 v141, v142, v163
  v_fma_f32 v146, -v165, v163, v146
  v_fma_f32 v140, -v143, v163, v140
  v_fmac_f32 v147, v165, v162
  v_fmac_f32 v141, v143, v162
  v_perm_b32 v7, v147, v146, s58
  v_perm_b32 v6, v141, v140, s58
  ds_write_addtid_b32 v7 offset:4624
  ds_write_addtid_b32 v6 offset:544
  v_mul_f32 v144, v146, v162
  v_mul_f32 v142, v140, v162
  v_mul_f32 v145, v146, v163
  v_mul_f32 v143, v140, v163
  v_fma_f32 v144, -v147, v163, v144
  v_fma_f32 v142, -v141, v163, v142
  v_fmac_f32 v145, v147, v162
  v_fmac_f32 v143, v141, v162
  v_perm_b32 v8, v145, v144, s58
  v_perm_b32 v5, v143, v142, s58
  ds_write_addtid_b32 v8 offset:4896
  ds_write_addtid_b32 v5 offset:816
  v_mul_f32 v146, v144, v162
  v_mul_f32 v122, v172, v166
  v_mul_f32 v147, v144, v163
  v_mul_f32 v123, v173, v166
  v_fma_f32 v146, -v145, v163, v146
  v_fmac_f32 v122, v173, v167
  v_fmac_f32 v147, v145, v162
  v_fma_f32 v123, -v172, v167, v123
  v_perm_b32 v7, v147, v146, s58
  v_perm_b32 v12, v123, v122, s58
  ds_write_addtid_b32 v7 offset:5168
  ds_write_addtid_b32 v12 offset:14144
  v_mul_f32 v140, v142, v162
  v_mul_f32 v144, v146, v162
  v_mul_f32 v141, v142, v163
  v_mul_f32 v145, v146, v163
  v_fma_f32 v140, -v143, v163, v140
  v_fma_f32 v144, -v147, v163, v144
  v_fmac_f32 v141, v143, v162
  v_fmac_f32 v145, v147, v162
  v_perm_b32 v6, v141, v140, s58
  v_perm_b32 v8, v145, v144, s58
  ds_write_addtid_b32 v6 offset:1088
  ds_write_addtid_b32 v8 offset:5440
  v_mul_f32 v124, v122, v168
  v_mul_f32 v142, v140, v162
  v_mul_f32 v125, v123, v168
  v_mul_f32 v143, v140, v163
  v_fmac_f32 v124, v123, v169
  v_fma_f32 v142, -v141, v163, v142
  v_fma_f32 v125, -v122, v169, v125
  v_fmac_f32 v143, v141, v162
  v_perm_b32 v11, v125, v124, s58
  v_perm_b32 v5, v143, v142, s58
  ds_write_addtid_b32 v11 offset:11696
  ds_write_addtid_b32 v5 offset:1360
  v_mul_f32 v146, v144, v162
  v_mul_f32 v152, v124, v168
  v_mul_f32 v147, v144, v163
  v_mul_f32 v153, v125, v168
  v_fma_f32 v146, -v145, v163, v146
  v_fmac_f32 v152, v125, v169
  v_fmac_f32 v147, v145, v162
  v_fma_f32 v153, -v124, v169, v153
  v_perm_b32 v7, v147, v146, s58
  v_perm_b32 v12, v153, v152, s58
  ds_write_addtid_b32 v7 offset:5712
  ds_write_addtid_b32 v12 offset:10064
  v_mul_f32 v140, v142, v162
  v_mul_f32 v144, v146, v162
  v_mul_f32 v141, v142, v163
  v_mul_f32 v145, v146, v163
  v_fma_f32 v140, -v143, v163, v140
  v_fma_f32 v144, -v147, v163, v144
  v_fmac_f32 v141, v143, v162
  v_fmac_f32 v145, v147, v162
  v_perm_b32 v6, v141, v140, s58
  v_perm_b32 v8, v145, v144, s58
  ds_write_addtid_b32 v6 offset:1632
  ds_write_addtid_b32 v8 offset:5984
  v_mul_f32 v124, v152, v168
  v_mul_f32 v142, v140, v162
  v_mul_f32 v125, v153, v168
  v_mul_f32 v143, v140, v163
  v_fmac_f32 v124, v153, v169
  v_fma_f32 v142, -v141, v163, v142
  v_fma_f32 v125, -v152, v169, v125
  v_fmac_f32 v143, v141, v162
  v_perm_b32 v11, v125, v124, s58
  v_perm_b32 v5, v143, v142, s58
  ds_write_addtid_b32 v11 offset:9792
  ds_write_addtid_b32 v5 offset:1904
  v_mul_f32 v146, v144, v162
  v_mul_f32 v120, v122, v166
  v_mul_f32 v147, v144, v163
  v_mul_f32 v121, v123, v166
  v_fma_f32 v146, -v145, v163, v146
  v_fmac_f32 v120, v123, v167
  v_fmac_f32 v147, v145, v162
  v_fma_f32 v121, -v122, v167, v121
  v_perm_b32 v7, v147, v146, s58
  v_perm_b32 v12, v121, v120, s58
  ds_write_addtid_b32 v7 offset:6256
  ds_write_addtid_b32 v12 offset:11968
  v_mul_f32 v140, v142, v162
  v_mul_f32 v144, v146, v162
  v_mul_f32 v141, v142, v163
  v_mul_f32 v145, v146, v163
  s_cmp_gt_u32 s3, 3
  s_cbranch_scc1 Lskip_1011
  buffer_load_dwordx4 v[20:23], v252, s[8:11], s59 offen offset:2048
Lskip_1011:
  v_fma_f32 v140, -v143, v163, v140
  v_fma_f32 v144, -v147, v163, v144
  v_fmac_f32 v141, v143, v162
  v_fmac_f32 v145, v147, v162
  v_perm_b32 v6, v141, v140, s58
  v_perm_b32 v8, v145, v144, s58
  ds_write_addtid_b32 v6 offset:2176
  ds_write_addtid_b32 v8 offset:6528
  v_mul_f32 v124, v120, v170
  v_mul_f32 v142, v140, v162
  v_mul_f32 v125, v121, v170
  v_mul_f32 v143, v140, v163
  v_fmac_f32 v124, v121, v171
  v_fma_f32 v142, -v141, v163, v142
  v_fma_f32 v125, -v120, v171, v125
  v_fmac_f32 v143, v141, v162
  v_perm_b32 v11, v125, v124, s58
  v_perm_b32 v5, v143, v142, s58
  ds_write_addtid_b32 v11 offset:12240
  ds_write_addtid_b32 v5 offset:2448
  v_mul_f32 v146, v144, v162
  v_mul_f32 v150, v172, v160
  v_mul_f32 v147, v144, v163
  v_mul_f32 v151, v173, v160
  v_fma_f32 v146, -v145, v163, v146
  v_fmac_f32 v150, v173, v161
  v_fmac_f32 v147, v145, v162
  v_fma_f32 v151, -v172, v161, v151
  v_perm_b32 v7, v147, v146, s58
  v_perm_b32 v9, v151, v150, s58
  ds_write_addtid_b32 v7 offset:6800
  ds_write_addtid_b32 v9 offset:8976
  v_mul_f32 v122, v120, v166
  v_mul_f32 v140, v142, v162
  v_mul_f32 v123, v121, v166
  v_mul_f32 v141, v142, v163
  v_fmac_f32 v122, v121, v167
  v_fma_f32 v140, -v143, v163, v140
  v_fma_f32 v123, -v120, v167, v123
  v_fmac_f32 v141, v143, v162
  v_perm_b32 v12, v123, v122, s58
  v_perm_b32 v6, v141, v140, s58
  ds_write_addtid_b32 v12 offset:10880
  ds_write_addtid_b32 v6 offset:2720
  v_mul_f32 v144, v146, v162
  v_mul_f32 v148, v150, v160
  v_mul_f32 v145, v146, v163
  v_mul_f32 v149, v151, v160
  v_fma_f32 v144, -v147, v163, v144
  v_fmac_f32 v148, v151, v161
  v_fmac_f32 v145, v147, v162
  v_fma_f32 v149, -v150, v161, v149
  v_perm_b32 v8, v145, v144, s58
  v_perm_b32 v10, v149, v148, s58
  ds_write_addtid_b32 v8 offset:7072
  ds_write_addtid_b32 v10 offset:9248
  v_mul_f32 v124, v122, v170
  v_mul_f32 v142, v140, v162
  v_mul_f32 v125, v123, v170
  v_mul_f32 v143, v140, v163
  v_fmac_f32 v124, v123, v171
  v_fma_f32 v142, -v141, v163, v142
  v_fma_f32 v125, -v122, v171, v125
  v_fmac_f32 v143, v141, v162
  v_perm_b32 v11, v125, v124, s58
  v_perm_b32 v5, v143, v142, s58
  ds_write_addtid_b32 v11 offset:11152
  ds_write_addtid_b32 v5 offset:2992
  v_mul_f32 v146, v144, v162
  v_mul_f32 v150, v148, v160
  v_mul_f32 v147, v144, v163
  v_mul_f32 v151, v149, v160
  v_fma_f32 v146, -v145, v163, v146
  v_fmac_f32 v150, v149, v161
  v_fmac_f32 v147, v145, v162
  v_fma_f32 v151, -v148, v161, v151
  v_perm_b32 v7, v147, v146, s58
  v_perm_b32 v9, v151, v150, s58
  ds_write_addtid_b32 v7 offset:7344
  ds_write_addtid_b32 v9 offset:9520
  v_mul_f32 v120, v122, v166
  v_mul_f32 v140, v142, v162
  v_mul_f32 v121, v123, v166
  v_mul_f32 v141, v142, v163
  v_fmac_f32 v120, v123, v167
  v_fma_f32 v140, -v143, v163, v140
  v_fma_f32 v121, -v122, v167, v121
  v_fmac_f32 v141, v143, v162
  v_perm_b32 v12, v121, v120, s58
  v_perm_b32 v6, v141, v140, s58
  ds_write_addtid_b32 v12 offset:10336
  ds_write_addtid_b32 v6 offset:3264
  v_mul_f32 v144, v146, v162
  v_mul_f32 v148, v150, v160
  v_mul_f32 v145, v146, v163
  v_mul_f32 v149, v151, v160
  v_fma_f32 v144, -v147, v163, v144
  v_fmac_f32 v148, v151, v161
  v_fmac_f32 v145, v147, v162
  v_fma_f32 v149, -v150, v161, v149
  v_perm_b32 v8, v145, v144, s58
  v_perm_b32 v10, v149, v148, s58
  ds_write_addtid_b32 v8 offset:7616
  ds_write_addtid_b32 v10 offset:13056
  v_mul_f32 v122, v120, v166
  v_mul_f32 v142, v140, v162
  v_mul_f32 v123, v121, v166
  v_mul_f32 v143, v140, v163
  v_fmac_f32 v122, v121, v167
  v_fma_f32 v142, -v141, v163, v142
  s_cmp_gt_u32 s3, 3
  s_cbranch_scc1 Lskip_1012
  buffer_load_dwordx4 v[24:27], v252, s[8:11], s37 offen offset:0
Lskip_1012:
  v_fma_f32 v123, -v120, v167, v123
  v_fmac_f32 v143, v141, v162
  v_perm_b32 v11, v123, v122, s58
  v_perm_b32 v5, v143, v142, s58
  ds_write_addtid_b32 v11 offset:10608
  ds_write_addtid_b32 v5 offset:3536
  v_mul_f32 v146, v144, v162
  v_mul_f32 v150, v148, v160
  v_mul_f32 v147, v144, v163
  v_mul_f32 v151, v149, v160
  v_fma_f32 v146, -v145, v163, v146
  v_fmac_f32 v150, v149, v161
  v_fmac_f32 v147, v145, v162
  v_fma_f32 v151, -v148, v161, v151
  v_perm_b32 v7, v147, v146, s58
  v_perm_b32 v9, v151, v150, s58
  ds_write_addtid_b32 v7 offset:7888
  ds_write_addtid_b32 v9 offset:13328
  v_mul_f32 v120, v122, v166
  v_mul_f32 v140, v142, v162
  v_mul_f32 v121, v123, v166
  v_mul_f32 v141, v142, v163
  v_fmac_f32 v120, v123, v167
  v_fma_f32 v140, -v143, v163, v140
  v_fma_f32 v121, -v122, v167, v121
  v_fmac_f32 v141, v143, v162
  v_perm_b32 v12, v121, v120, s58
  v_perm_b32 v6, v141, v140, s58
  ds_write_addtid_b32 v12 offset:11424
  ds_write_addtid_b32 v6 offset:3808
  v_mul_f32 v144, v146, v162
  v_mul_f32 v148, v150, v160
  v_mul_f32 v145, v146, v163
  v_mul_f32 v149, v151, v160
  v_fma_f32 v144, -v147, v163, v144
  v_fmac_f32 v148, v151, v161
  v_fmac_f32 v145, v147, v162
  v_fma_f32 v149, -v150, v161, v149
  v_perm_b32 v8, v145, v144, s58
  v_perm_b32 v10, v149, v148, s58
  ds_write_addtid_b32 v8 offset:8160
  ds_write_addtid_b32 v10 offset:13600
  v_mul_f32 v122, v120, v166
  v_mul_f32 v142, v140, v162
  v_mul_f32 v123, v121, v166
  v_mul_f32 v143, v140, v163
  v_fmac_f32 v122, v121, v167
  v_fma_f32 v142, -v141, v163, v142
  v_fma_f32 v123, -v120, v167, v123
  v_fmac_f32 v143, v141, v162
  v_perm_b32 v11, v123, v122, s58
  v_perm_b32 v5, v143, v142, s58
  ds_write_addtid_b32 v11 offset:12512
  ds_write_addtid_b32 v5 offset:4080
  v_mul_f32 v146, v144, v162
  v_mul_f32 v150, v148, v160
  v_mul_f32 v147, v144, v163
  v_mul_f32 v151, v149, v160
  v_fma_f32 v146, -v145, v163, v146
  v_fmac_f32 v150, v149, v161
  v_fmac_f32 v147, v145, v162
  v_fma_f32 v151, -v148, v161, v151
  v_perm_b32 v7, v147, v146, s58
  v_perm_b32 v9, v151, v150, s58
  ds_write_addtid_b32 v7 offset:8432
  ds_write_addtid_b32 v9 offset:13872
  v_mul_f32 v124, v122, v162
  v_mul_f32 v125, v123, v162
  v_fmac_f32 v124, v123, v163
  v_fma_f32 v125, -v122, v163, v125
  v_perm_b32 v12, v125, v124, s58
  ds_write_addtid_b32 v12 offset:12784
  ds_read_b128 v[56:59], v232 offset:0
  ds_read_b128 v[60:63], v233 offset:0
  ds_read_b128 v[64:67], v232 offset:32
  ds_read_b128 v[68:71], v233 offset:32
  ds_read_b128 v[72:75], v232 offset:64
  ds_read_b128 v[76:79], v233 offset:64
  ds_read_b128 v[80:83], v232 offset:96
  ds_read_b128 v[84:87], v233 offset:96
  ds_read_b128 v[88:91], v232 offset:128
  ds_read_b128 v[92:95], v233 offset:128
  ds_read_b128 v[96:99], v232 offset:160
  ds_read_b128 v[100:103], v233 offset:160
  ds_read_b128 v[104:107], v232 offset:192
  ds_read_b128 v[108:111], v233 offset:192
  ds_read_b128 v[112:115], v232 offset:224
  ds_read_b128 v[116:119], v233 offset:224
  s_waitcnt lgkmcnt(14)
  v_mfma_f32_32x32x16_bf16 v[40:55], v[56:59], v[60:63], v[40:55]
  s_waitcnt lgkmcnt(12)
  v_mfma_f32_32x32x16_bf16 v[40:55], v[64:67], v[68:71], v[40:55]
  s_waitcnt lgkmcnt(10)
  v_mfma_f32_32x32x16_bf16 v[40:55], v[72:75], v[76:79], v[40:55]
  s_waitcnt lgkmcnt(8)
  v_mfma_f32_32x32x16_bf16 v[40:55], v[80:83], v[84:87], v[40:55]
  s_waitcnt lgkmcnt(6)
  v_mfma_f32_32x32x16_bf16 v[40:55], v[88:91], v[92:95], v[40:55]
  s_waitcnt lgkmcnt(4)
  v_mfma_f32_32x32x16_bf16 v[40:55], v[96:99], v[100:103], v[40:55]
  s_waitcnt lgkmcnt(2)
  v_mfma_f32_32x32x16_bf16 v[40:55], v[104:107], v[108:111], v[40:55]
  s_waitcnt lgkmcnt(0)
  v_mfma_f32_32x32x16_bf16 v[40:55], v[112:115], v[116:119], v[40:55]
  s_setprio 0
  v_mov_b32 v6, 0
  v_mov_b32 v7, 0
  v_mov_b32 v8, 0
  v_mov_b32 v9, 0
  ds_write_b128 v236, v[6:9] offset:0
  ds_write_b128 v236, v[6:9] offset:1536
  ds_write_b128 v236, v[6:9] offset:3072
  ds_write_b32 v235, v6 offset:8
  ds_write_b32 v228, v6
  s_cmp_gt_u32 s3, 3
  s_cbranch_scc1 Lskip_1013
  buffer_load_dwordx4 v[28:31], v252, s[8:11], s37 offen offset:2048
Lskip_1013:
  v_mov_b32 v64, 0
  v_mov_b32 v68, 0
  s_mov_b64 exec, 1
  v_add_f32 v40, v40, v249
  s_mov_b64 exec, -1
  v_mov_b32_dpp v47, v48 wave_rol:1 row_mask:0x8 bank_mask:0xf
  v_mov_b32_dpp v50, v51 wave_rol:1 row_mask:0x8 bank_mask:0xf
  v_mov_b32_dpp v52, v53 wave_rol:1 row_mask:0x8 bank_mask:0xf
  v_mov_b32_dpp v47, v40 wave_shl:1 row_mask:0xc bank_mask:0xf
  v_mov_b32_dpp v50, v48 wave_shl:1 row_mask:0xf bank_mask:0xf
  v_mov_b32_dpp v52, v51 wave_shl:1 row_mask:0xf bank_mask:0xf
  v_mov_b32_dpp v54, v53 wave_shl:1 row_mask:0x3 bank_mask:0xf
  v_cvt_pk_bf16_f32 v9, v48, v48
  v_cvt_pk_bf16_f32 v13, v51, v51
  v_cvt_pk_bf16_f32 v56, v40, v41
  v_cvt_pk_bf16_f32 v57, v42, v43
  v_cvt_pk_bf16_f32 v58, v44, v45
  v_cvt_pk_bf16_f32 v59, v46, v47
  v_readlane_b32 s29, v9, 0
  v_readlane_b32 s30, v13, 0
  ds_write_b128 v234, v[56:59] offset:32
  v_mov_b32_dpp v8, v47 wave_shr:1 row_mask:0xf bank_mask:0xf
  v_cvt_pk_bf16_f32 v61, v41, v42
  v_cvt_pk_bf16_f32 v62, v43, v44
  v_cvt_pk_bf16_f32 v63, v45, v46
  v_cvt_pk_bf16_f32 v60, v8, v40
  v_mov_b32 v65, v56
  v_mov_b32 v66, v57
  v_mov_b32 v67, v58
  v_mov_b32_dpp v64, v59 wave_shr:1 row_mask:0xf bank_mask:0xf
  ds_write_b128 v234, v[60:63] offset:1248
  v_mov_b32 v69, v60
  v_mov_b32 v70, v61
  v_mov_b32 v71, v62
  v_mov_b32_dpp v68, v63 wave_shr:1 row_mask:0xf bank_mask:0xf
  ds_write_b128 v234, v[64:67] offset:2464
  v_readlane_b32 s28, v59, 63
  v_readlane_b32 s31, v63, 63
  v_and_b32 v9, s29, v246
  v_and_b32 v13, s30, v229
  ds_write_b128 v234, v[68:71] offset:3680
  v_cvt_pk_bf16_f32 v10, v51, v52
  v_cvt_pk_bf16_f32 v11, v53, v54
  v_mov_b32_dpp v14, v50 quad_perm:[1,1,3,3] row_mask:0xf bank_mask:0xf
  v_writelane_b32 v9, s28, 32
  v_writelane_b32 v9, s31, 48
  s_mov_b32 vcc_lo, 0xaaaaaaaa
  s_mov_b32 vcc_hi, 0xaaaaaaaa
  v_mov_b32_dpp v12, v11 quad_perm:[1,1,3,3] row_mask:0xf bank_mask:0xf
  ds_write_b32 v228, v13 offset:32
  v_cndmask_b32 v14, v14, v48, vcc
  ds_write_b32 v235, v9 offset:1056
  v_cndmask_b32 v12, v12, v10, vcc
  v_cvt_pk_bf16_f32 v14, v14, v49
  ds_write_b16_d16_hi v237, v12 offset:3168
  ds_write_b16 v237, v12 offset:3936
  ds_write_b16_d16_hi v237, v12 offset:3362
  ds_write_b16 v237, v12 offset:4130
  ds_write_b16_d16_hi v237, v12 offset:3556
  ds_write_b16 v237, v12 offset:4324
  ds_write_b16_d16_hi v237, v12 offset:3750
  ds_write_b16 v237, v12 offset:4518
  ds_write_b16 v230, v14 offset:32
  ds_write_b16_d16_hi v230, v14 offset:800
  ds_write_b16 v230, v14 offset:226
  ds_write_b16_d16_hi v230, v14 offset:994
  ds_write_b16 v230, v14 offset:420
  ds_write_b16_d16_hi v230, v14 offset:1188
  ds_write_b16 v230, v14 offset:614
  ds_write_b16_d16_hi v230, v14 offset:1382
  s_cmp_gt_u32 s3, 3
  s_cbranch_scc1 Lskip_1014
  s_waitcnt vmcnt(6)
  v_perm_b32 v120, v180, v176, s57
  s_waitcnt vmcnt(4)
  v_perm_b32 v121, v188, v184, s57
  ds_write_b64 v238, v[120:121] offset:0
  v_perm_b32 v122, v180, v176, s58
  v_perm_b32 v123, v188, v184, s58
  ds_write_b64 v238, v[122:123] offset:4608
  v_perm_b32 v124, v181, v177, s57
  v_perm_b32 v125, v189, v185, s57
  ds_write_b64 v238, v[124:125] offset:9216
  v_perm_b32 v126, v181, v177, s58
  v_perm_b32 v127, v189, v185, s58
  ds_write_b64 v238, v[126:127] offset:13824
  v_perm_b32 v128, v182, v178, s57
  v_perm_b32 v129, v190, v186, s57
  ds_write_b64 v238, v[128:129] offset:18432
  v_perm_b32 v130, v182, v178, s58
  v_perm_b32 v131, v190, v186, s58
  ds_write_b64 v238, v[130:131] offset:23040
  v_perm_b32 v132, v183, v179, s57
  v_perm_b32 v133, v191, v187, s57
  ds_write_b64 v238, v[132:133] offset:27648
  v_perm_b32 v134, v183, v179, s58
  v_perm_b32 v135, v191, v187, s58
  ds_write_b64 v238, v[134:135] offset:32256
Lskip_1014:
  s_waitcnt lgkmcnt(0)
  s_barrier
  s_setprio 2
  ds_read_b128 v[64:67], v241 offset:480
  ds_read_b64_tr_b16 v[56:57], v240 offset:64
  ds_read_b64_tr_b16 v[58:59], v240 offset:56
  ds_read_b128 v[68:71], v241 offset:992
  ds_read_b64_tr_b16 v[60:61], v240 offset:576
  ds_read_b64_tr_b16 v[62:63], v240 offset:568
  ds_read_b128 v[72:75], v241 offset:1504
  ds_read_b128 v[76:79], v241 offset:2016
  ds_read_b64_tr_b16 v[212:213], v240 offset:1088
  ds_read_b64_tr_b16 v[214:215], v240 offset:1080
  ds_read_b64_tr_b16 v[216:217], v226 offset:64
  ds_read_b64_tr_b16 v[218:219], v226 offset:56
  s_waitcnt lgkmcnt(9)
  v_mfma_f32_16x16x32_bf16 v[160:163], v[56:59], v[64:67], 0
  ds_read_b128 v[92:95], v241 offset:416
  ds_read_b64_tr_b16 v[84:85], v240 offset:128
  s_waitcnt lgkmcnt(10)
  v_mfma_f32_16x16x32_bf16 v[164:167], v[56:59], v[68:71], 0
  ds_read_b64_tr_b16 v[86:87], v240 offset:120
  ds_read_b128 v[96:99], v241 offset:928
  s_waitcnt lgkmcnt(10)
  v_mfma_f32_16x16x32_bf16 v[164:167], v[60:63], v[64:67], v[164:167]
  ds_read_b64_tr_b16 v[88:89], v240 offset:640
  ds_read_b64_tr_b16 v[90:91], v240 offset:632
  v_mfma_f32_16x16x32_bf16 v[168:171], v[60:63], v[68:71], 0
  ds_read_b128 v[100:103], v241 offset:1440
  ds_read_b128 v[104:107], v241 offset:1952
  s_waitcnt lgkmcnt(6)
  v_mfma_f32_16x16x32_bf16 v[168:171], v[56:59], v[72:75], v[168:171]
  ds_read_b128 v[192:195], v225 offset:0
  ds_read_b128 v[196:199], v225 offset:1024
  v_mfma_f32_16x16x32_bf16 v[172:175], v[60:63], v[72:75], 0
  ds_read_b128 v[200:203], v225 offset:2048
  ds_read_b128 v[204:207], v225 offset:3072
  v_mfma_f32_16x16x32_bf16 v[172:175], v[56:59], v[76:79], v[172:175]
  ds_read_b128 v[208:211], v225 offset:4096
  ds_read_b64_tr_b16 v[120:121], v242 offset:32
  v_mfma_f32_16x16x32_bf16 v[168:171], v[212:215], v[64:67], v[168:171]
  ds_read_b64_tr_b16 v[128:129], v242 offset:64
  v_mfma_f32_16x16x32_bf16 v[172:175], v[212:215], v[68:71], v[172:175]
  v_mfma_f32_16x16x32_bf16 v[176:179], v[212:215], v[72:75], 0
  v_mfma_f32_16x16x32_bf16 v[180:183], v[212:215], v[76:79], 0
  v_mfma_f32_16x16x32_bf16 v[176:179], v[216:219], v[64:67], v[176:179]
  v_mfma_f32_16x16x32_bf16 v[180:183], v[216:219], v[68:71], v[180:183]
  v_mfma_f32_16x16x32_bf16 v[184:187], v[216:219], v[72:75], 0
  v_mfma_f32_16x16x32_bf16 v[188:191], v[216:219], v[76:79], 0
  s_waitcnt lgkmcnt(0)
  v_mfma_f32_16x16x32_bf16 v[160:163], v[84:87], v[92:95], v[160:163]
  ds_read_b128 v[64:67], v241 offset:352
  ds_read_b64_tr_b16 v[56:57], v240 offset:192
  ds_read_b64_tr_b16 v[58:59], v240 offset:184
  v_mfma_f32_16x16x32_bf16 v[164:167], v[84:87], v[96:99], v[164:167]
  ds_read_b128 v[68:71], v241 offset:864
  ds_read_b64_tr_b16 v[60:61], v240 offset:704
  ds_read_b64_tr_b16 v[62:63], v240 offset:696
  v_mfma_f32_16x16x32_bf16 v[164:167], v[88:91], v[92:95], v[164:167]
  ds_read_b128 v[72:75], v241 offset:1376
  ds_read_b128 v[76:79], v241 offset:1888
  ds_read_b64_tr_b16 v[136:137], v242 offset:96
  v_mfma_f32_16x16x32_bf16 v[168:171], v[88:91], v[96:99], v[168:171]
  ds_read_b64_tr_b16 v[122:123], v242 offset:800
  ds_read_b64_tr_b16 v[130:131], v242 offset:832
  ds_read_b64_tr_b16 v[138:139], v242 offset:864
  v_mfma_f32_16x16x32_bf16 v[168:171], v[84:87], v[100:103], v[168:171]
  ds_read_b64_tr_b16 v[124:125], v242 offset:1568
  ds_read_b64_tr_b16 v[132:133], v242 offset:1600
  ds_read_b64_tr_b16 v[140:141], v242 offset:1632
  v_mfma_f32_16x16x32_bf16 v[172:175], v[88:91], v[100:103], v[172:175]
  v_mfma_f32_16x16x32_bf16 v[172:175], v[84:87], v[104:107], v[172:175]
  s_waitcnt lgkmcnt(3)
  v_mfma_f32_16x16x32_bf16 v[160:163], v[56:59], v[64:67], v[160:163]
  ds_read_b64_tr_b16 v[126:127], v242 offset:2336
  ds_read_b64_tr_b16 v[134:135], v242 offset:2368
  v_mfma_f32_16x16x32_bf16 v[164:167], v[56:59], v[68:71], v[164:167]
  ds_read_b64_tr_b16 v[142:143], v242 offset:2400
  ds_read_b64_tr_b16 v[144:145], v242 offset:3104
  v_mfma_f32_16x16x32_bf16 v[164:167], v[60:63], v[64:67], v[164:167]
  ds_read_b64_tr_b16 v[146:147], v242 offset:3872
  ds_read_b64_tr_b16 v[148:149], v242 offset:3136
  v_mfma_f32_16x16x32_bf16 v[168:171], v[60:63], v[68:71], v[168:171]
  ds_read_b64_tr_b16 v[150:151], v242 offset:3904
  ds_read_b128 v[112:115], v241 offset:464
  v_mfma_f32_16x16x32_bf16 v[168:171], v[56:59], v[72:75], v[168:171]
  ds_read_b128 v[116:119], v241 offset:480
  ds_read_b128 v[92:95], v241 offset:288
  v_mfma_f32_16x16x32_bf16 v[172:175], v[60:63], v[72:75], v[172:175]
  ds_read_b64_tr_b16 v[84:85], v240 offset:256
  v_mfma_f32_16x16x32_bf16 v[172:175], v[56:59], v[76:79], v[172:175]
  s_waitcnt lgkmcnt(3)
  v_mfma_f32_16x16x32_bf16 v[212:215], v[112:115], v[200:203], 0
  ds_read_b64_tr_b16 v[86:87], v240 offset:248
  ds_read_b128 v[96:99], v241 offset:800
  s_waitcnt lgkmcnt(3)
  v_mfma_f32_16x16x32_bf16 v[216:219], v[116:119], v[204:207], 0
  ds_read_b64_tr_b16 v[88:89], v240 offset:768
  ds_read_b64_tr_b16 v[90:91], v240 offset:760
  v_mfma_f32_16x16x32_bf16 v[220:223], v[116:119], v[200:203], 0
  ds_read_b128 v[100:103], v241 offset:1312
  ds_read_b128 v[104:107], v241 offset:1824
  v_mfma_f32_16x16x32_bf16 v[224:227], v[116:119], v[208:211], 0
  v_mfma_f32_16x16x32_bf16 v[228:231], v[112:115], v[192:195], 0
  v_mfma_f32_16x16x32_bf16 v[52:55], v[116:119], v[196:199], 0
  s_waitcnt lgkmcnt(0)
  v_mfma_f32_16x16x32_bf16 v[160:163], v[84:87], v[92:95], v[160:163]
  ds_read_b64_tr_b16 v[152:153], v242 offset:3168
  ds_read_b64_tr_b16 v[154:155], v242 offset:3936
  v_mfma_f32_16x16x32_bf16 v[164:167], v[84:87], v[96:99], v[164:167]
  ds_read_b64_tr_b16 v[156:157], v242 offset:3200
  ds_read_b64_tr_b16 v[158:159], v242 offset:3968
  v_cvt_pk_bf16_f32 v40, v212, v213
  v_cvt_pk_bf16_f32 v41, v214, v215
  v_cvt_pk_bf16_f32 v42, v216, v217
  v_mfma_f32_16x16x32_bf16 v[164:167], v[88:91], v[92:95], v[164:167]
  ds_read_b128 v[112:115], v241 offset:976
  ds_read_b128 v[116:119], v241 offset:992
  v_cvt_pk_bf16_f32 v43, v218, v219
  v_cvt_pk_bf16_f32 v44, v220, v221
  v_cvt_pk_bf16_f32 v45, v222, v223
  v_mfma_f32_16x16x32_bf16 v[168:171], v[88:91], v[96:99], v[168:171]
  ds_read_b128 v[64:67], v241 offset:224
  ds_read_b64_tr_b16 v[56:57], v240 offset:320
  v_cvt_pk_bf16_f32 v46, v224, v225
  v_cvt_pk_bf16_f32 v47, v226, v227
  v_cvt_pk_bf16_f32 v48, v228, v229
  v_mfma_f32_16x16x32_bf16 v[168:171], v[84:87], v[100:103], v[168:171]
  v_cvt_pk_bf16_f32 v49, v230, v231
  v_cvt_pk_bf16_f32 v50, v52, v53
  v_cvt_pk_bf16_f32 v51, v54, v55
  v_mfma_f32_16x16x32_bf16 v[172:175], v[88:91], v[100:103], v[172:175]
  v_mfma_f32_16x16x32_bf16 v[172:175], v[84:87], v[104:107], v[172:175]
  v_mfma_f32_16x16x32_bf16 v[168:171], v[40:43], v[120:123], v[168:171]
  ds_read_b64_tr_b16 v[58:59], v240 offset:312
  v_mfma_f32_16x16x32_bf16 v[172:175], v[40:43], v[128:131], v[172:175]
  ds_read_b128 v[68:71], v241 offset:736
  v_mfma_f32_16x16x32_bf16 v[176:179], v[40:43], v[136:139], v[176:179]
  ds_read_b64_tr_b16 v[60:61], v240 offset:832
  v_mfma_f32_16x16x32_bf16 v[168:171], v[44:47], v[124:127], v[168:171]
  ds_read_b64_tr_b16 v[62:63], v240 offset:824
  v_mfma_f32_16x16x32_bf16 v[172:175], v[44:47], v[132:135], v[172:175]
  ds_read_b128 v[72:75], v241 offset:1248
  v_mfma_f32_16x16x32_bf16 v[176:179], v[44:47], v[140:143], v[176:179]
  ds_read_b128 v[76:79], v241 offset:1760
  v_mfma_f32_16x16x32_bf16 v[176:179], v[48:51], v[144:147], v[176:179]
  v_mfma_f32_16x16x32_bf16 v[180:183], v[48:51], v[148:151], v[180:183]
  s_waitcnt lgkmcnt(1)
  v_mfma_f32_16x16x32_bf16 v[184:187], v[48:51], v[152:155], v[184:187]
  v_mfma_f32_16x16x32_bf16 v[188:191], v[48:51], v[156:159], v[188:191]
  v_mfma_f32_16x16x32_bf16 v[212:215], v[112:115], v[200:203], 0
  v_mfma_f32_16x16x32_bf16 v[216:219], v[116:119], v[204:207], 0
  v_mfma_f32_16x16x32_bf16 v[220:223], v[116:119], v[200:203], 0
  v_mfma_f32_16x16x32_bf16 v[224:227], v[116:119], v[208:211], 0
  v_mfma_f32_16x16x32_bf16 v[228:231], v[112:115], v[192:195], 0
  v_mfma_f32_16x16x32_bf16 v[52:55], v[116:119], v[196:199], 0
  v_mfma_f32_16x16x32_bf16 v[160:163], v[56:59], v[64:67], v[160:163]
  ds_read_b128 v[92:95], v241 offset:160
  v_mfma_f32_16x16x32_bf16 v[164:167], v[56:59], v[68:71], v[164:167]
  ds_read_b64_tr_b16 v[84:85], v240 offset:384
  v_cvt_pk_bf16_f32 v40, v212, v213
  v_cvt_pk_bf16_f32 v41, v214, v215
  v_cvt_pk_bf16_f32 v42, v216, v217
  v_mfma_f32_16x16x32_bf16 v[164:167], v[60:63], v[64:67], v[164:167]
  v_cvt_pk_bf16_f32 v43, v218, v219
  v_cvt_pk_bf16_f32 v44, v220, v221
  v_cvt_pk_bf16_f32 v45, v222, v223
  v_mfma_f32_16x16x32_bf16 v[168:171], v[60:63], v[68:71], v[168:171]
  v_cvt_pk_bf16_f32 v46, v224, v225
  v_cvt_pk_bf16_f32 v47, v226, v227
  v_cvt_pk_bf16_f32 v48, v228, v229
  v_mfma_f32_16x16x32_bf16 v[168:171], v[56:59], v[72:75], v[168:171]
  v_cvt_pk_bf16_f32 v49, v230, v231
  v_cvt_pk_bf16_f32 v50, v52, v53
  v_cvt_pk_bf16_f32 v51, v54, v55
  v_mfma_f32_16x16x32_bf16 v[172:175], v[60:63], v[72:75], v[172:175]
  s_waitcnt lgkmcnt(0)
  v_mfma_f32_16x16x32_bf16 v[172:175], v[56:59], v[76:79], v[172:175]
  v_mfma_f32_16x16x32_bf16 v[172:175], v[40:43], v[120:123], v[172:175]
  ds_read_b64_tr_b16 v[86:87], v240 offset:376
  v_mfma_f32_16x16x32_bf16 v[176:179], v[40:43], v[128:131], v[176:179]
  ds_read_b128 v[96:99], v241 offset:672
  v_mfma_f32_16x16x32_bf16 v[180:183], v[40:43], v[136:139], v[180:183]
  ds_read_b64_tr_b16 v[88:89], v240 offset:896
  v_mfma_f32_16x16x32_bf16 v[172:175], v[44:47], v[124:127], v[172:175]
  ds_read_b64_tr_b16 v[90:91], v240 offset:888
  v_mfma_f32_16x16x32_bf16 v[176:179], v[44:47], v[132:135], v[176:179]
  ds_read_b128 v[100:103], v241 offset:1184
  v_mfma_f32_16x16x32_bf16 v[180:183], v[44:47], v[140:143], v[180:183]
  ds_read_b128 v[104:107], v241 offset:1696
  v_mfma_f32_16x16x32_bf16 v[180:183], v[48:51], v[144:147], v[180:183]
  v_mfma_f32_16x16x32_bf16 v[184:187], v[48:51], v[148:151], v[184:187]
  v_mfma_f32_16x16x32_bf16 v[188:191], v[48:51], v[152:155], v[188:191]
  s_waitcnt lgkmcnt(0)
  v_mfma_f32_16x16x32_bf16 v[160:163], v[84:87], v[92:95], v[160:163]
  ds_read_b128 v[64:67], v241 offset:96
  ds_read_b64_tr_b16 v[56:57], v240 offset:448
  v_mfma_f32_16x16x32_bf16 v[164:167], v[84:87], v[96:99], v[164:167]
  ds_read_b64_tr_b16 v[58:59], v240 offset:440
  ds_read_b128 v[68:71], v241 offset:608
  v_mfma_f32_16x16x32_bf16 v[164:167], v[88:91], v[92:95], v[164:167]
  ds_read_b64_tr_b16 v[60:61], v240 offset:960
  ds_read_b64_tr_b16 v[62:63], v240 offset:952
  v_mfma_f32_16x16x32_bf16 v[168:171], v[88:91], v[96:99], v[168:171]
  ds_read_b128 v[72:75], v241 offset:1120
  ds_read_b128 v[76:79], v241 offset:1632
  v_mfma_f32_16x16x32_bf16 v[168:171], v[84:87], v[100:103], v[168:171]
  v_mfma_f32_16x16x32_bf16 v[172:175], v[88:91], v[100:103], v[172:175]
  v_mfma_f32_16x16x32_bf16 v[172:175], v[84:87], v[104:107], v[172:175]
  s_waitcnt lgkmcnt(0)
  v_mfma_f32_16x16x32_bf16 v[160:163], v[56:59], v[64:67], v[160:163]
  ds_read_b128 v[92:95], v241 offset:32
  ds_read_b64_tr_b16 v[84:85], v240 offset:512
  v_mfma_f32_16x16x32_bf16 v[164:167], v[56:59], v[68:71], v[164:167]
  ds_read_b64_tr_b16 v[86:87], v240 offset:504
  ds_read_b128 v[96:99], v241 offset:544
  v_mfma_f32_16x16x32_bf16 v[164:167], v[60:63], v[64:67], v[164:167]
  ds_read_b64_tr_b16 v[88:89], v240 offset:1024
  ds_read_b64_tr_b16 v[90:91], v240 offset:1016
  v_mfma_f32_16x16x32_bf16 v[168:171], v[60:63], v[68:71], v[168:171]
  ds_read_b128 v[100:103], v241 offset:1056
  ds_read_b128 v[104:107], v241 offset:1568
  v_mfma_f32_16x16x32_bf16 v[168:171], v[56:59], v[72:75], v[168:171]
  v_mfma_f32_16x16x32_bf16 v[172:175], v[60:63], v[72:75], v[172:175]
  v_mfma_f32_16x16x32_bf16 v[172:175], v[56:59], v[76:79], v[172:175]
  s_waitcnt lgkmcnt(0)
  v_mfma_f32_16x16x32_bf16 v[160:163], v[84:87], v[92:95], v[160:163]
  v_mfma_f32_16x16x32_bf16 v[164:167], v[84:87], v[96:99], v[164:167]
  v_mfma_f32_16x16x32_bf16 v[164:167], v[88:91], v[92:95], v[164:167]
  v_mfma_f32_16x16x32_bf16 v[168:171], v[88:91], v[96:99], v[168:171]
  v_mfma_f32_16x16x32_bf16 v[168:171], v[84:87], v[100:103], v[168:171]
  v_mfma_f32_16x16x32_bf16 v[172:175], v[88:91], v[100:103], v[172:175]
  v_mfma_f32_16x16x32_bf16 v[172:175], v[84:87], v[104:107], v[172:175]
  s_cmp_gt_u32 s3, 3
  s_cbranch_scc1 Lskip_1015
  s_waitcnt vmcnt(2)
  v_perm_b32 v212, v20, v16, s57
  s_waitcnt vmcnt(0)
  v_perm_b32 v213, v28, v24, s57
  ds_write_b64 v238, v[212:213] offset:2048
  v_perm_b32 v214, v20, v16, s58
  v_perm_b32 v215, v28, v24, s58
  ds_write_b64 v238, v[214:215] offset:6656
  v_perm_b32 v216, v21, v17, s57
  v_perm_b32 v217, v29, v25, s57
  ds_write_b64 v238, v[216:217] offset:11264
  v_perm_b32 v218, v21, v17, s58
  v_perm_b32 v219, v29, v25, s58
  ds_write_b64 v238, v[218:219] offset:15872
  v_perm_b32 v220, v22, v18, s57
  v_perm_b32 v221, v30, v26, s57
  ds_write_b64 v238, v[220:221] offset:20480
  v_perm_b32 v222, v22, v18, s58
  v_perm_b32 v223, v30, v26, s58
  ds_write_b64 v238, v[222:223] offset:25088
  v_perm_b32 v224, v23, v19, s57
  v_perm_b32 v225, v31, v27, s57
  ds_write_b64 v238, v[224:225] offset:29696
  v_perm_b32 v226, v23, v19, s58
  v_perm_b32 v227, v31, v27, s58
  ds_write_b64 v238, v[226:227] offset:34304
  s_waitcnt lgkmcnt(0)
  s_mov_b64 exec, 1
  ds_add_u32 v247, v253 offset:4
  s_mov_b64 exec, -1
Lskip_1015:
  v_cvt_pk_bf16_f32 v6, v160, v161
  v_cvt_pk_bf16_f32 v7, v162, v163
  ds_write_b64 v243, v[6:7] offset:0
  v_cvt_pk_bf16_f32 v8, v164, v165
  v_cvt_pk_bf16_f32 v9, v166, v167
  ds_write_b64 v243, v[8:9] offset:512
  v_cvt_pk_bf16_f32 v10, v168, v169
  v_cvt_pk_bf16_f32 v11, v170, v171
  ds_write_b64 v243, v[10:11] offset:1024
  v_cvt_pk_bf16_f32 v12, v172, v173
  v_cvt_pk_bf16_f32 v13, v174, v175
  ds_write_b64 v243, v[12:13] offset:1536
  s_waitcnt lgkmcnt(0)
  s_mov_b64 exec, 1
  ds_add_u32 v247, v253 offset:0
  s_mov_b64 exec, -1
  s_setprio 1
  s_mov_b32 s31, 1000000
Lspin_1016:
  ds_read_b32 v15, v247 offset:4
  s_waitcnt lgkmcnt(0)
  v_readfirstlane_b32 s29, v15
  s_nop 0
  s_cmp_eq_u32 s29, 4
  s_cbranch_scc1 Lspun_1017
  s_sub_u32 s31, s31, 1
  s_cmp_lg_u32 s31, 0
  s_cbranch_scc1 Lspin_1016
Lspun_1017:
  ds_read_b128 v[64:67], v241 offset:2016
  ds_read_b64_tr_b16 v[56:57], v240 offset:64
  ds_read_b64_tr_b16 v[58:59], v240 offset:56
  ds_read_b128 v[68:71], v241 offset:2528
  ds_read_b64_tr_b16 v[60:61], v240 offset:576
  ds_read_b64_tr_b16 v[62:63], v240 offset:568
  ds_read_b128 v[72:75], v241 offset:3040
  ds_read_b64_tr_b16 v[32:33], v240 offset:1088
  ds_read_b64_tr_b16 v[34:35], v240 offset:1080
  s_waitcnt lgkmcnt(3)
  v_mfma_f32_16x16x32_bf16 v[176:179], v[60:63], v[64:67], v[176:179]
  ds_read_b128 v[92:95], v241 offset:1952
  ds_read_b64_tr_b16 v[84:85], v240 offset:128
  v_mfma_f32_16x16x32_bf16 v[176:179], v[56:59], v[68:71], v[176:179]
  ds_read_b64_tr_b16 v[86:87], v240 offset:120
  ds_read_b128 v[96:99], v241 offset:2464
  v_mfma_f32_16x16x32_bf16 v[180:183], v[60:63], v[68:71], v[180:183]
  ds_read_b64_tr_b16 v[88:89], v240 offset:640
  ds_read_b64_tr_b16 v[90:91], v240 offset:632
  s_waitcnt lgkmcnt(6)
  v_mfma_f32_16x16x32_bf16 v[180:183], v[56:59], v[72:75], v[180:183]
  ds_read_b128 v[100:103], v241 offset:2976
  v_mfma_f32_16x16x32_bf16 v[184:187], v[32:35], v[68:71], v[184:187]
  v_mfma_f32_16x16x32_bf16 v[188:191], v[32:35], v[72:75], v[188:191]
  s_cmp_gt_u32 s3, 3
  s_cbranch_scc1 Lskip_1018
  s_mul_i32 s29, s3, 512
  s_mul_i32 s30, s3, 1048576
  v_add_u32 v5, s29, v244
  v_add_u32 v14, s30, v245
  v_xor_b32 v6, 8, v5
  v_xor_b32 v7, 16, v5
  v_xor_b32 v8, 24, v5
  s_mov_b32 s31, 1000000
Lspin_1019:
  ds_read_b32 v15, v247 offset:0
  s_waitcnt lgkmcnt(0)
  v_readfirstlane_b32 s29, v15
  s_nop 0
  s_cmp_eq_u32 s29, 8
  s_cbranch_scc1 Lspun_1020
  s_sub_u32 s31, s31, 1
  s_cmp_lg_u32 s31, 0
  s_cbranch_scc1 Lspin_1019
Lspun_1020:
  ds_read_b64_tr_b16 v[16:17], v5 offset:0
  ds_read_b64_tr_b16 v[18:19], v5 offset:58624
  ds_read_b64_tr_b16 v[20:21], v6 offset:128
  ds_read_b64_tr_b16 v[22:23], v6 offset:58752
  ds_read_b64_tr_b16 v[24:25], v7 offset:256
  ds_read_b64_tr_b16 v[26:27], v7 offset:58880
  ds_read_b64_tr_b16 v[28:29], v8 offset:384
  ds_read_b64_tr_b16 v[30:31], v8 offset:59008
  s_mov_b32 s28, 0
  s_waitcnt lgkmcnt(6)
  buffer_store_dwordx4 v[16:19], v14, s[20:23], s28 offen
Lskip_1018:
  s_waitcnt lgkmcnt(1)
  v_mfma_f32_16x16x32_bf16 v[176:179], v[88:91], v[92:95], v[176:179]
  ds_read_b128 v[64:67], v241 offset:1888
  ds_read_b64_tr_b16 v[56:57], v240 offset:192
  ds_read_b64_tr_b16 v[58:59], v240 offset:184
  v_mfma_f32_16x16x32_bf16 v[176:179], v[84:87], v[96:99], v[176:179]
  ds_read_b128 v[68:71], v241 offset:2400
  ds_read_b64_tr_b16 v[60:61], v240 offset:704
  ds_read_b64_tr_b16 v[62:63], v240 offset:696
  v_mfma_f32_16x16x32_bf16 v[180:183], v[88:91], v[96:99], v[180:183]
  ds_read_b128 v[72:75], v241 offset:2912
  s_waitcnt lgkmcnt(7)
  v_mfma_f32_16x16x32_bf16 v[180:183], v[84:87], v[100:103], v[180:183]
  s_cmp_gt_u32 s3, 3
  s_cbranch_scc1 Lskip_1021
  s_mov_b32 s28, 262144
  buffer_store_dwordx4 v[20:23], v14, s[20:23], s28 offen
Lskip_1021:
  s_waitcnt lgkmcnt(1)
  v_mfma_f32_16x16x32_bf16 v[176:179], v[60:63], v[64:67], v[176:179]
  ds_read_b128 v[112:115], v241 offset:1488
  ds_read_b128 v[116:119], v241 offset:1504
  v_mfma_f32_16x16x32_bf16 v[176:179], v[56:59], v[68:71], v[176:179]
  ds_read_b128 v[92:95], v241 offset:1824
  ds_read_b64_tr_b16 v[84:85], v240 offset:256
  v_mfma_f32_16x16x32_bf16 v[180:183], v[60:63], v[68:71], v[180:183]
  s_waitcnt lgkmcnt(4)
  v_mfma_f32_16x16x32_bf16 v[180:183], v[56:59], v[72:75], v[180:183]
  s_cmp_gt_u32 s3, 3
  s_cbranch_scc1 Lskip_1022
  s_mov_b32 s28, 524288
  buffer_store_dwordx4 v[24:27], v14, s[20:23], s28 offen
Lskip_1022:
  s_waitcnt lgkmcnt(2)
  v_mfma_f32_16x16x32_bf16 v[212:215], v[112:115], v[200:203], 0
  ds_read_b64_tr_b16 v[86:87], v240 offset:248
  v_mfma_f32_16x16x32_bf16 v[216:219], v[116:119], v[204:207], 0
  ds_read_b128 v[96:99], v241 offset:2336
  v_mfma_f32_16x16x32_bf16 v[220:223], v[116:119], v[200:203], 0
  ds_read_b64_tr_b16 v[88:89], v240 offset:768
  v_mfma_f32_16x16x32_bf16 v[224:227], v[116:119], v[208:211], 0
  ds_read_b64_tr_b16 v[90:91], v240 offset:760
  v_mfma_f32_16x16x32_bf16 v[228:231], v[112:115], v[192:195], 0
  ds_read_b128 v[100:103], v241 offset:2848
  v_mfma_f32_16x16x32_bf16 v[52:55], v[116:119], v[196:199], 0
  s_waitcnt lgkmcnt(1)
  v_mfma_f32_16x16x32_bf16 v[176:179], v[88:91], v[92:95], v[176:179]
  ds_read_b128 v[112:115], v241 offset:2000
  ds_read_b128 v[116:119], v241 offset:2016
  v_mfma_f32_16x16x32_bf16 v[176:179], v[84:87], v[96:99], v[176:179]
  ds_read_b128 v[64:67], v241 offset:1760
  ds_read_b64_tr_b16 v[56:57], v240 offset:320
  v_cvt_pk_bf16_f32 v40, v212, v213
  v_cvt_pk_bf16_f32 v41, v214, v215
  v_cvt_pk_bf16_f32 v42, v216, v217
  v_cvt_pk_bf16_f32 v43, v218, v219
  v_cvt_pk_bf16_f32 v44, v220, v221
  v_cvt_pk_bf16_f32 v45, v222, v223
  v_mfma_f32_16x16x32_bf16 v[180:183], v[88:91], v[96:99], v[180:183]
  v_cvt_pk_bf16_f32 v46, v224, v225
  v_cvt_pk_bf16_f32 v47, v226, v227
  v_cvt_pk_bf16_f32 v48, v228, v229
  v_cvt_pk_bf16_f32 v49, v230, v231
  v_cvt_pk_bf16_f32 v50, v52, v53
  v_cvt_pk_bf16_f32 v51, v54, v55
  s_waitcnt lgkmcnt(4)
  v_mfma_f32_16x16x32_bf16 v[180:183], v[84:87], v[100:103], v[180:183]
  s_cmp_gt_u32 s3, 3
  s_cbranch_scc1 Lskip_1023
  s_mov_b32 s28, 786432
  buffer_store_dwordx4 v[28:31], v14, s[20:23], s28 offen
Lskip_1023:
  v_mfma_f32_16x16x32_bf16 v[176:179], v[40:43], v[120:123], v[176:179]
  ds_read_b64_tr_b16 v[58:59], v240 offset:312
  v_mfma_f32_16x16x32_bf16 v[180:183], v[40:43], v[128:131], v[180:183]
  ds_read_b128 v[68:71], v241 offset:2272
  v_mfma_f32_16x16x32_bf16 v[184:187], v[40:43], v[136:139], v[184:187]
  ds_read_b64_tr_b16 v[60:61], v240 offset:832
  v_mfma_f32_16x16x32_bf16 v[176:179], v[44:47], v[124:127], v[176:179]
  ds_read_b64_tr_b16 v[62:63], v240 offset:824
  v_mfma_f32_16x16x32_bf16 v[180:183], v[44:47], v[132:135], v[180:183]
  ds_read_b128 v[72:75], v241 offset:2784
  v_mfma_f32_16x16x32_bf16 v[184:187], v[44:47], v[140:143], v[184:187]
  v_mfma_f32_16x16x32_bf16 v[184:187], v[48:51], v[144:147], v[184:187]
  v_mfma_f32_16x16x32_bf16 v[188:191], v[48:51], v[148:151], v[188:191]
  s_waitcnt lgkmcnt(0)
  v_mfma_f32_16x16x32_bf16 v[212:215], v[112:115], v[200:203], 0
  v_mfma_f32_16x16x32_bf16 v[216:219], v[116:119], v[204:207], 0
  v_mfma_f32_16x16x32_bf16 v[220:223], v[116:119], v[200:203], 0
  v_mfma_f32_16x16x32_bf16 v[224:227], v[116:119], v[208:211], 0
  v_mfma_f32_16x16x32_bf16 v[228:231], v[112:115], v[192:195], 0
  v_mfma_f32_16x16x32_bf16 v[52:55], v[116:119], v[196:199], 0
  v_mfma_f32_16x16x32_bf16 v[176:179], v[60:63], v[64:67], v[176:179]
  ds_read_b128 v[92:95], v241 offset:1696
  v_mfma_f32_16x16x32_bf16 v[176:179], v[56:59], v[68:71], v[176:179]
  ds_read_b64_tr_b16 v[84:85], v240 offset:384
  v_cvt_pk_bf16_f32 v40, v212, v213
  v_cvt_pk_bf16_f32 v41, v214, v215
  v_cvt_pk_bf16_f32 v42, v216, v217
  v_cvt_pk_bf16_f32 v43, v218, v219
  v_cvt_pk_bf16_f32 v44, v220, v221
  v_cvt_pk_bf16_f32 v45, v222, v223
  v_mfma_f32_16x16x32_bf16 v[180:183], v[60:63], v[68:71], v[180:183]
  v_cvt_pk_bf16_f32 v46, v224, v225
  v_cvt_pk_bf16_f32 v47, v226, v227
  v_cvt_pk_bf16_f32 v48, v228, v229
  v_cvt_pk_bf16_f32 v49, v230, v231
  v_cvt_pk_bf16_f32 v50, v52, v53
  v_cvt_pk_bf16_f32 v51, v54, v55
  v_mfma_f32_16x16x32_bf16 v[180:183], v[56:59], v[72:75], v[180:183]
  v_mfma_f32_16x16x32_bf16 v[180:183], v[40:43], v[120:123], v[180:183]
  ds_read_b64_tr_b16 v[86:87], v240 offset:376
  v_mfma_f32_16x16x32_bf16 v[184:187], v[40:43], v[128:131], v[184:187]
  ds_read_b128 v[96:99], v241 offset:2208
  v_mfma_f32_16x16x32_bf16 v[188:191], v[40:43], v[136:139], v[188:191]
  ds_read_b64_tr_b16 v[88:89], v240 offset:896
  v_mfma_f32_16x16x32_bf16 v[180:183], v[44:47], v[124:127], v[180:183]
  ds_read_b64_tr_b16 v[90:91], v240 offset:888
  v_mfma_f32_16x16x32_bf16 v[184:187], v[44:47], v[132:135], v[184:187]
  ds_read_b128 v[100:103], v241 offset:2720
  v_mfma_f32_16x16x32_bf16 v[188:191], v[44:47], v[140:143], v[188:191]
  v_mfma_f32_16x16x32_bf16 v[188:191], v[48:51], v[144:147], v[188:191]
  s_waitcnt lgkmcnt(1)
  v_mfma_f32_16x16x32_bf16 v[176:179], v[88:91], v[92:95], v[176:179]
  ds_read_b128 v[64:67], v241 offset:1632
  ds_read_b64_tr_b16 v[56:57], v240 offset:448
  ds_read_b64_tr_b16 v[58:59], v240 offset:440
  v_mfma_f32_16x16x32_bf16 v[176:179], v[84:87], v[96:99], v[176:179]
  ds_read_b128 v[68:71], v241 offset:2144
  ds_read_b64_tr_b16 v[60:61], v240 offset:960
  ds_read_b64_tr_b16 v[62:63], v240 offset:952
  v_mfma_f32_16x16x32_bf16 v[180:183], v[88:91], v[96:99], v[180:183]
  ds_read_b128 v[72:75], v241 offset:2656
  s_waitcnt lgkmcnt(7)
  v_mfma_f32_16x16x32_bf16 v[180:183], v[84:87], v[100:103], v[180:183]
  s_waitcnt lgkmcnt(1)
  v_mfma_f32_16x16x32_bf16 v[176:179], v[60:63], v[64:67], v[176:179]
  ds_read_b128 v[92:95], v241 offset:1568
  ds_read_b64_tr_b16 v[84:85], v240 offset:512
  ds_read_b64_tr_b16 v[86:87], v240 offset:504
  v_mfma_f32_16x16x32_bf16 v[176:179], v[56:59], v[68:71], v[176:179]
  ds_read_b128 v[96:99], v241 offset:2080
  ds_read_b64_tr_b16 v[88:89], v240 offset:1024
  ds_read_b64_tr_b16 v[90:91], v240 offset:1016
  v_mfma_f32_16x16x32_bf16 v[180:183], v[60:63], v[68:71], v[180:183]
  ds_read_b128 v[100:103], v241 offset:2592
  s_waitcnt lgkmcnt(7)
  v_mfma_f32_16x16x32_bf16 v[180:183], v[56:59], v[72:75], v[180:183]
  s_waitcnt lgkmcnt(1)
  v_mfma_f32_16x16x32_bf16 v[176:179], v[88:91], v[92:95], v[176:179]
  ds_read_b128 v[64:67], v241 offset:3040
  ds_read_b64_tr_b16 v[56:57], v240 offset:64
  ds_read_b64_tr_b16 v[58:59], v240 offset:56
  v_mfma_f32_16x16x32_bf16 v[176:179], v[84:87], v[96:99], v[176:179]
  ds_read_b128 v[68:71], v241 offset:3552
  ds_read_b64_tr_b16 v[60:61], v240 offset:576
  ds_read_b64_tr_b16 v[62:63], v240 offset:568
  v_mfma_f32_16x16x32_bf16 v[180:183], v[88:91], v[96:99], v[180:183]
  ds_read_b128 v[72:75], v241 offset:4064
  s_waitcnt lgkmcnt(7)
  v_mfma_f32_16x16x32_bf16 v[180:183], v[84:87], v[100:103], v[180:183]
  s_nop 0
  v_cvt_pk_bf16_f32 v6, v176, v177
  v_cvt_pk_bf16_f32 v7, v178, v179
  ds_write_b64 v243, v[6:7] offset:2048
  s_nop 3
  v_cvt_pk_bf16_f32 v8, v180, v181
  v_cvt_pk_bf16_f32 v9, v182, v183
  ds_write_b64 v243, v[8:9] offset:2560
  s_waitcnt lgkmcnt(0)
  s_mov_b64 exec, 1
  ds_add_u32 v247, v253 offset:8
  s_mov_b64 exec, -1
  s_setprio 0
  v_mfma_f32_16x16x32_bf16 v[184:187], v[60:63], v[64:67], v[184:187]
  ds_read_b128 v[92:95], v241 offset:2976
  ds_read_b64_tr_b16 v[84:85], v240 offset:128
  ds_read_b64_tr_b16 v[86:87], v240 offset:120
  v_mfma_f32_16x16x32_bf16 v[184:187], v[56:59], v[68:71], v[184:187]
  ds_read_b128 v[96:99], v241 offset:3488
  ds_read_b64_tr_b16 v[88:89], v240 offset:640
  ds_read_b64_tr_b16 v[90:91], v240 offset:632
  v_mfma_f32_16x16x32_bf16 v[188:191], v[60:63], v[68:71], v[188:191]
  ds_read_b128 v[100:103], v241 offset:4000
  v_mfma_f32_16x16x32_bf16 v[188:191], v[56:59], v[72:75], v[188:191]
  s_cmp_gt_u32 s3, 3
  s_cbranch_scc1 Lskip_1024
  s_mul_i32 s29, s3, 256
  s_mul_i32 s30, s3, 524288
  v_add_u32 v5, s29, v244
  v_add_u32 v14, s30, v245
  s_mul_i32 s29, s3, 16
  s_and_b32 s29, s29, 24
  v_xor_b32 v5, s29, v5
  v_xor_b32 v6, 8, v5
  s_mov_b32 s31, 1000000
Lspin_1025:
  ds_read_b32 v15, v247 offset:8
  s_waitcnt lgkmcnt(0)
  v_readfirstlane_b32 s29, v15
  s_nop 0
  s_cmp_eq_u32 s29, 8
  s_cbranch_scc1 Lspun_1026
  s_sub_u32 s31, s31, 1
  s_cmp_lg_u32 s31, 0
  s_cbranch_scc1 Lspin_1025
Lspun_1026:
  ds_read_b64_tr_b16 v[16:17], v5 offset:2048
  ds_read_b64_tr_b16 v[18:19], v5 offset:60672
  ds_read_b64_tr_b16 v[20:21], v6 offset:2176
  ds_read_b64_tr_b16 v[22:23], v6 offset:60800
  s_mov_b32 s28, 4194304
  s_waitcnt lgkmcnt(2)
  buffer_store_dwordx4 v[16:19], v14, s[20:23], s28 offen
Lskip_1024:
  s_waitcnt lgkmcnt(1)
  v_mfma_f32_16x16x32_bf16 v[184:187], v[88:91], v[92:95], v[184:187]
  ds_read_b128 v[64:67], v241 offset:2912
  ds_read_b64_tr_b16 v[56:57], v240 offset:192
  ds_read_b64_tr_b16 v[58:59], v240 offset:184
  v_mfma_f32_16x16x32_bf16 v[184:187], v[84:87], v[96:99], v[184:187]
  ds_read_b128 v[68:71], v241 offset:3424
  ds_read_b64_tr_b16 v[60:61], v240 offset:704
  ds_read_b64_tr_b16 v[62:63], v240 offset:696
  v_mfma_f32_16x16x32_bf16 v[188:191], v[88:91], v[96:99], v[188:191]
  ds_read_b128 v[72:75], v241 offset:3936
  s_waitcnt lgkmcnt(7)
  v_mfma_f32_16x16x32_bf16 v[188:191], v[84:87], v[100:103], v[188:191]
  s_cmp_gt_u32 s3, 3
  s_cbranch_scc1 Lskip_1027
  s_mov_b32 s28, 4456448
  buffer_store_dwordx4 v[20:23], v14, s[20:23], s28 offen
Lskip_1027:
  s_waitcnt lgkmcnt(1)
  v_mfma_f32_16x16x32_bf16 v[184:187], v[60:63], v[64:67], v[184:187]
  ds_read_b128 v[112:115], v241 offset:2512
  ds_read_b128 v[116:119], v241 offset:2528
  v_mfma_f32_16x16x32_bf16 v[184:187], v[56:59], v[68:71], v[184:187]
  ds_read_b128 v[92:95], v241 offset:2848
  ds_read_b64_tr_b16 v[84:85], v240 offset:256
  v_mfma_f32_16x16x32_bf16 v[188:191], v[60:63], v[68:71], v[188:191]
  s_waitcnt lgkmcnt(4)
  v_mfma_f32_16x16x32_bf16 v[188:191], v[56:59], v[72:75], v[188:191]
  s_waitcnt lgkmcnt(2)
  v_mfma_f32_16x16x32_bf16 v[212:215], v[112:115], v[200:203], 0
  ds_read_b64_tr_b16 v[86:87], v240 offset:248
  ds_read_b128 v[96:99], v241 offset:3360
  v_mfma_f32_16x16x32_bf16 v[216:219], v[116:119], v[204:207], 0
  ds_read_b64_tr_b16 v[88:89], v240 offset:768
  ds_read_b64_tr_b16 v[90:91], v240 offset:760
  v_mfma_f32_16x16x32_bf16 v[220:223], v[116:119], v[200:203], 0
  ds_read_b128 v[100:103], v241 offset:3872
  v_mfma_f32_16x16x32_bf16 v[224:227], v[116:119], v[208:211], 0
  s_waitcnt lgkmcnt(1)
  v_mfma_f32_16x16x32_bf16 v[184:187], v[88:91], v[92:95], v[184:187]
  ds_read_b128 v[112:115], v241 offset:3024
  ds_read_b128 v[116:119], v241 offset:3040
  v_mfma_f32_16x16x32_bf16 v[184:187], v[84:87], v[96:99], v[184:187]
  ds_read_b128 v[64:67], v241 offset:2784
  ds_read_b64_tr_b16 v[56:57], v240 offset:320
  v_cvt_pk_bf16_f32 v40, v212, v213
  v_cvt_pk_bf16_f32 v41, v214, v215
  v_cvt_pk_bf16_f32 v42, v216, v217
  v_cvt_pk_bf16_f32 v43, v218, v219
  v_mfma_f32_16x16x32_bf16 v[188:191], v[88:91], v[96:99], v[188:191]
  v_cvt_pk_bf16_f32 v44, v220, v221
  v_cvt_pk_bf16_f32 v45, v222, v223
  v_cvt_pk_bf16_f32 v46, v224, v225
  v_cvt_pk_bf16_f32 v47, v226, v227
  s_waitcnt lgkmcnt(4)
  v_mfma_f32_16x16x32_bf16 v[188:191], v[84:87], v[100:103], v[188:191]
  v_mfma_f32_16x16x32_bf16 v[184:187], v[40:43], v[120:123], v[184:187]
  ds_read_b64_tr_b16 v[58:59], v240 offset:312
  v_mfma_f32_16x16x32_bf16 v[188:191], v[40:43], v[128:131], v[188:191]
  ds_read_b128 v[68:71], v241 offset:3296
  v_mfma_f32_16x16x32_bf16 v[184:187], v[44:47], v[124:127], v[184:187]
  ds_read_b64_tr_b16 v[60:61], v240 offset:832
  v_mfma_f32_16x16x32_bf16 v[188:191], v[44:47], v[132:135], v[188:191]
  ds_read_b64_tr_b16 v[62:63], v240 offset:824
  s_waitcnt lgkmcnt(3)
  v_mfma_f32_16x16x32_bf16 v[212:215], v[112:115], v[200:203], 0
  ds_read_b128 v[72:75], v241 offset:3808
  v_mfma_f32_16x16x32_bf16 v[216:219], v[116:119], v[204:207], 0
  v_mfma_f32_16x16x32_bf16 v[220:223], v[116:119], v[200:203], 0
  v_mfma_f32_16x16x32_bf16 v[224:227], v[116:119], v[208:211], 0
  s_waitcnt lgkmcnt(0)
  v_mfma_f32_16x16x32_bf16 v[184:187], v[60:63], v[64:67], v[184:187]
  ds_read_b128 v[92:95], v241 offset:2720
  v_mfma_f32_16x16x32_bf16 v[184:187], v[56:59], v[68:71], v[184:187]
  ds_read_b64_tr_b16 v[84:85], v240 offset:384
  v_cvt_pk_bf16_f32 v40, v212, v213
  v_cvt_pk_bf16_f32 v41, v214, v215
  v_cvt_pk_bf16_f32 v42, v216, v217
  v_cvt_pk_bf16_f32 v43, v218, v219
  v_mfma_f32_16x16x32_bf16 v[188:191], v[60:63], v[68:71], v[188:191]
  v_cvt_pk_bf16_f32 v44, v220, v221
  v_cvt_pk_bf16_f32 v45, v222, v223
  v_cvt_pk_bf16_f32 v46, v224, v225
  v_cvt_pk_bf16_f32 v47, v226, v227
  v_mfma_f32_16x16x32_bf16 v[188:191], v[56:59], v[72:75], v[188:191]
  v_mfma_f32_16x16x32_bf16 v[188:191], v[40:43], v[120:123], v[188:191]
  ds_read_b64_tr_b16 v[86:87], v240 offset:376
  ds_read_b128 v[96:99], v241 offset:3232
  ds_read_b64_tr_b16 v[88:89], v240 offset:896
  ds_read_b64_tr_b16 v[90:91], v240 offset:888
  ds_read_b128 v[100:103], v241 offset:3744
  v_mfma_f32_16x16x32_bf16 v[188:191], v[44:47], v[124:127], v[188:191]
  s_waitcnt lgkmcnt(1)
  v_mfma_f32_16x16x32_bf16 v[184:187], v[88:91], v[92:95], v[184:187]
  ds_read_b128 v[64:67], v241 offset:2656
  ds_read_b64_tr_b16 v[56:57], v240 offset:448
  ds_read_b64_tr_b16 v[58:59], v240 offset:440
  v_mfma_f32_16x16x32_bf16 v[184:187], v[84:87], v[96:99], v[184:187]
  ds_read_b128 v[68:71], v241 offset:3168
  ds_read_b64_tr_b16 v[60:61], v240 offset:960
  ds_read_b64_tr_b16 v[62:63], v240 offset:952
  v_mfma_f32_16x16x32_bf16 v[188:191], v[88:91], v[96:99], v[188:191]
  ds_read_b128 v[72:75], v241 offset:3680
  s_waitcnt lgkmcnt(7)
  v_mfma_f32_16x16x32_bf16 v[188:191], v[84:87], v[100:103], v[188:191]
  s_waitcnt lgkmcnt(1)
  v_mfma_f32_16x16x32_bf16 v[184:187], v[60:63], v[64:67], v[184:187]
  ds_read_b128 v[92:95], v241 offset:2592
  ds_read_b64_tr_b16 v[84:85], v240 offset:512
  ds_read_b64_tr_b16 v[86:87], v240 offset:504
  v_mfma_f32_16x16x32_bf16 v[184:187], v[56:59], v[68:71], v[184:187]
  ds_read_b128 v[96:99], v241 offset:3104
  ds_read_b64_tr_b16 v[88:89], v240 offset:1024
  ds_read_b64_tr_b16 v[90:91], v240 offset:1016
  v_mfma_f32_16x16x32_bf16 v[188:191], v[60:63], v[68:71], v[188:191]
  ds_read_b128 v[100:103], v241 offset:3616
  s_waitcnt lgkmcnt(7)
  v_mfma_f32_16x16x32_bf16 v[188:191], v[56:59], v[72:75], v[188:191]
  s_waitcnt lgkmcnt(1)
  v_mfma_f32_16x16x32_bf16 v[184:187], v[88:91], v[92:95], v[184:187]
  v_mfma_f32_16x16x32_bf16 v[184:187], v[84:87], v[96:99], v[184:187]
  v_mfma_f32_16x16x32_bf16 v[188:191], v[88:91], v[96:99], v[188:191]
  s_waitcnt lgkmcnt(0)
  v_mfma_f32_16x16x32_bf16 v[188:191], v[84:87], v[100:103], v[188:191]
  s_nop 4
  v_cvt_pk_bf16_f32 v6, v184, v185
  v_cvt_pk_bf16_f32 v7, v186, v187
  ds_write_b64 v243, v[6:7] offset:3072
  v_cvt_pk_bf16_f32 v8, v188, v189
  v_cvt_pk_bf16_f32 v9, v190, v191
  ds_write_b64 v243, v[8:9] offset:3584
  s_waitcnt lgkmcnt(0)
  s_mul_i32 s29, s3, 128
  s_mul_i32 s30, s3, 262144
  v_add_u32 v5, s29, v244
  v_add_u32 v14, s30, v245
  s_mul_i32 s29, s3, 8
  s_and_b32 s29, s29, 24
  v_xor_b32 v5, s29, v5
  s_barrier
  ds_read_b64_tr_b16 v[16:17], v5 offset:3072
  ds_read_b64_tr_b16 v[18:19], v5 offset:61696
  s_mov_b32 s28, 6291456
  s_waitcnt lgkmcnt(0)
  buffer_store_dwordx4 v[16:19], v14, s[20:23], s28 offen
  s_endpgm
L_B_end:
L_exit:
  s_endpgm
.section .rodata,"a"
.p2align 6
.amdhsa_kernel concat_heads__spectral_gfnet__ssm_conv_s4__prompt_kernel
  .amdhsa_next_free_vgpr 256
  .amdhsa_next_free_sgpr 102
  .amdhsa_accum_offset 256
  .amdhsa_group_segment_fixed_size 0
  .amdhsa_kernarg_size 120
  .amdhsa_user_sgpr_count 2
  .amdhsa_user_sgpr_kernarg_segment_ptr 1
  .amdhsa_system_sgpr_workgroup_id_x 1
.end_amdhsa_kernel
```
